```python
import torch

def _softmax(x, axis=-1):
    return torch.softmax(x, dim=axis)
def _gelu(x):
    return torch.nn.functional.gelu(x, approximate="tanh")
def _silu(x):
    return torch.nn.functional.silu(x)
def _sigmoid(x):
    return torch.sigmoid(x)
def _layernorm(x, axis=-1, eps=1e-5):
    m = x.mean(dim=axis, keepdim=True)
    v = x.var(dim=axis, keepdim=True, unbiased=False)
    return (x - m) / torch.sqrt(v + eps)
def _scatter_add(tgt, idx, src, axis=0):
    return tgt.clone().index_add_(axis, idx, src)
def _segment_sum(src, seg, n):
    out = torch.zeros((n,) + src.shape[1:], dtype=src.dtype)
    return out.index_add_(0, seg, src)
def _pad(x, pw):
    flat = tuple(v for pair in reversed(pw) for v in pair)
    return torch.nn.functional.pad(x, flat)

kernel_name = 'interleave_layers__sliding_local_dilated__geglu_ffn__prompt'

def setup_inputs():

    _w = (lambda a: (lambda t: t.to(torch.bfloat16) if t.is_floating_point() else t)(torch.as_tensor(a)))
    def _A_setup():
        B, S, D = 1, 2048, 512
        return {
            "x": _w((lambda *s: torch.randn(*s, dtype=torch.bfloat16) * 0.05)(B, S, D)),
            "wqkv": _w((lambda *s: torch.randn(*s, dtype=torch.bfloat16) * 0.05)(D, 3 * D)),
            "wo": _w((lambda *s: torch.randn(*s, dtype=torch.bfloat16) * 0.05)(D, D)),
        }
    _A_in = _A_setup()

    def _B_setup():
        B, S, D, F = 1, 2048, 512, 1376
        return {
            "x": _w((lambda *s: torch.randn(*s, dtype=torch.bfloat16) * 0.05)(B, S, D)),
            "w_gate": _w((lambda *s: torch.randn(*s, dtype=torch.bfloat16) * 0.05)(D, F)),
            "w_up": _w((lambda *s: torch.randn(*s, dtype=torch.bfloat16) * 0.05)(D, F)),
            "w_down": _w((lambda *s: torch.randn(*s, dtype=torch.bfloat16) * 0.05)(F, D)),
        }
    _B_in = _B_setup()

    return {
        "A_x": _A_in["x"],
        "A_wqkv": _A_in["wqkv"],
        "A_wo": _A_in["wo"],
        "B_x": _B_in["x"],
        "B_w_gate": _B_in["w_gate"],
        "B_w_up": _B_in["w_up"],
        "B_w_down": _B_in["w_down"],
    }

def reference(A_x, A_wqkv, A_wo, B_x, B_w_gate, B_w_up, B_w_down):
    def _A_ref(x, wqkv, wo):
        B, S, D = x.shape
        H = 32; Dh = D // H
        W, dil = 8, 2
        qkv = (lambda x, *d: x.permute(*d))((x @ wqkv).reshape(B, S, 3, H, Dh), 2, 0, 3, 1, 4)
        q, k, v = qkv[0], qkv[1], qkv[2]
        scale = Dh ** -0.5
        pos = torch.arange(S)
        off = torch.arange(W) * dil
        idx = pos[:, None] - off[None, :]
        mask = idx >= 0
        idx_c = torch.where(mask, idx, 0).reshape(-1)
        kg = k[:, :, idx_c, :].reshape(B, H, S, W, Dh)
        vg = v[:, :, idx_c, :].reshape(B, H, S, W, Dh)
        logits = torch.einsum("bhsd,bhswd->bhsw", q, kg) * scale
        logits = torch.where(mask[None, None, :, :], logits, -1e9)
        attn = _softmax(logits, axis=-1)
        o = torch.einsum("bhsw,bhswd->bhsd", attn, vg)
        return (lambda x, *d: x.permute(*d))(o, 0, 2, 1, 3).reshape(B, S, D) @ wo

    def _B_ref(x, w_gate, w_up, w_down):
        return (_gelu(x @ w_gate) * (x @ w_up)) @ w_down

    x = A_x
    x = x + _A_ref(_layernorm(x, axis=-1), A_wqkv, A_wo)
    x = x + _B_ref(_layernorm(x, axis=-1), B_w_gate, B_w_up, B_w_down)
    x = x + _A_ref(_layernorm(x, axis=-1), A_wqkv, A_wo)
    x = x + _B_ref(_layernorm(x, axis=-1), B_w_gate, B_w_up, B_w_down)
    return x
```

```asm
; @launch grid=(256,1,1) block=(512,1,1) lds=163840
.amdgcn_target "amdgcn-amd-amdhsa--gfx950"
.text
.globl interleave_layers__sliding_local_dilated__geglu_ffn__prompt_kernel
.p2align 8
.type interleave_layers__sliding_local_dilated__geglu_ffn__prompt_kernel,@function
interleave_layers__sliding_local_dilated__geglu_ffn__prompt_kernel:
    s_cmp_ge_u32 s2, 256
    s_cbranch_scc1 L_end
    s_load_dwordx16 s[64:79], s[0:1], 0
    s_load_dwordx4 s[84:87], s[0:1], 64
    s_and_b32 s53, s2, 7
    s_lshr_b32 s54, s2, 3
    s_lshl_b32 s44, s53, 2
    s_lshr_b32 s55, s54, 3
    s_add_u32 s44, s44, s55
    s_and_b32 s45, s54, 7
    v_lshrrev_b32 v1, 6, v0
    v_and_b32 v15, 63, v0
    v_readfirstlane_b32 s46, v1
    v_lshlrev_b32 v1, 4, v15
    s_nop 2
    s_lshr_b32 s91, s46, 2
    s_and_b32 s46, s46, 3
    s_waitcnt lgkmcnt(0)
    s_mov_b32 s12, s64
    s_and_b32 s13, s65, 0xffff
    s_mov_b32 s14, 2097152
    s_mov_b32 s15, 0x20000
    s_mov_b32 s16, s66
    s_and_b32 s17, s67, 0xffff
    s_mov_b32 s18, 1572864
    s_mov_b32 s19, 0x20000
    s_mov_b32 s20, s68
    s_and_b32 s21, s69, 0xffff
    s_mov_b32 s22, 524288
    s_mov_b32 s23, 0x20000
    s_mov_b32 s32, s76
    s_and_b32 s33, s77, 0xffff
    s_mov_b32 s34, 1409024
    s_mov_b32 s35, 0x20000
    s_mov_b32 s36, s78
    s_and_b32 s37, s79, 0xffff
    s_mov_b32 s38, 2097152
    s_mov_b32 s39, 0x20000
    s_mov_b32 s40, s84
    s_and_b32 s41, s85, 0xffff
    s_mov_b32 s42, 256
    s_mov_b32 s43, 0x20000
    s_mov_b32 s8, s86
    s_and_b32 s9, s87, 0xffff
    s_mov_b32 s10, 37748736
    s_mov_b32 s11, 0x20000
    s_cmp_lt_u32 s46, 2
    s_cselect_b32 s24, s72, s74
    s_cselect_b32 s53, s73, s75
    s_and_b32 s25, s53, 0xffff
    s_mov_b32 s26, 1409024
    s_mov_b32 s27, 0x20000
    s_mul_i32 s59, s46, 3072
    s_lshl_b32 s60, s46, 10
    s_mul_i32 s61, s46, 5120
    s_mov_b32 s62, 0x3f803f80
    s_lshl_b32 s63, s44, 2
    s_add_u32 s63, s63, s46
    s_mov_b32 s48, 0
    s_mov_b32 s49, 0
    s_mov_b32 s50, 0
    s_mov_b32 s51, 0
    s_mov_b32 s52, 0
    s_and_b32 s53, s44, 1
    s_lshl_b32 s53, s53, 3
    s_add_u32 s53, s53, s45
    s_mul_i32 s54, s53, 3
    s_lshl_b32 s55, s53, 1
    s_add_u32 s55, s55, 11
    s_cmp_le_u32 s53, 10
    s_cselect_b32 s80, s54, s55
    s_cselect_b32 s81, 3, 2
    s_lshr_b32 s53, s44, 1
    s_lshl_b32 s53, s53, 2
    s_add_u32 s82, s53, s46
    s_lshl_b32 s54, s44, 2
    s_sub_u32 s55, s54, 1
    s_max_i32 s90, s55, 0
    s_getreg_b32 s100, hwreg(HW_REG_XCC_ID, 0, 4)
    s_mov_b32 s99, 0
    s_and_b32 s53, s63, 15
    s_cmp_eq_u32 s53, 15
    s_cselect_b32 s101, 1, 0
    s_cmp_lg_u32 s91, 0
    s_cbranch_scc1 L_loader
    s_or_b32 s53, s2, s46
    s_cmp_lg_u32 s53, 0
    s_cbranch_scc1 L_nonce_8
    s_memrealtime s[88:89]
    s_waitcnt lgkmcnt(0)
    s_waitcnt lgkmcnt(0)
    s_or_b32 s54, s88, 16
    s_andn2_b32 s54, s54, 15
    v_mov_b32 v20, s54
    v_mov_b32 v21, 0
    s_mov_b64 exec, 1
    buffer_store_dword v20, v21, s[40:43], 0 offen sc1
    s_mov_b64 exec, -1
L_nonce_8:
    s_nop 1
    v_and_b32 v20, 15, v15
    v_lshlrev_b32 v20, 10, v20
    v_lshrrev_b32 v21, 4, v15
    v_lshlrev_b32 v21, 3, v21
    v_add_u32 v20, v20, v21
    s_lshl_b32 s53, s63, 14
    s_lshl_b32 s54, s45, 7
    s_add_u32 s53, s53, s54
    buffer_load_dwordx2 v[2:3], v20, s[12:15], s53 offen offset:0
    buffer_load_dwordx2 v[4:5], v20, s[12:15], s53 offen offset:32
    buffer_load_dwordx2 v[6:7], v20, s[12:15], s53 offen offset:64
    buffer_load_dwordx2 v[8:9], v20, s[12:15], s53 offen offset:96
    v_mov_b32 v248, 0
    v_and_b32 v20, 15, v15
    v_lshrrev_b32 v21, 4, v15
    v_lshlrev_b32 v21, 2, v21
    v_add_u32 v22, 0, v21
    v_cmp_ge_u32 s[64:65], v20, v22
    v_add_u32 v22, 1, v21
    v_cmp_ge_u32 s[66:67], v20, v22
    v_add_u32 v22, 2, v21
    v_cmp_ge_u32 s[68:69], v20, v22
    v_add_u32 v22, 3, v21
    v_cmp_ge_u32 s[70:71], v20, v22
    v_and_b32 v23, 1, v20
    v_add_u32 v22, v21, v23
    v_cmp_ge_u32 s[72:73], v20, v22
    v_add_u32 v22, 2, v22
    v_cmp_ge_u32 s[74:75], v20, v22
    v_cmp_eq_u32 s[76:77], 0, v20
    s_mov_b64 s[78:79], 0xffff
    s_mov_b32 s84, 0xbdd2d3e8
    s_mov_b32 s85, 0xbdd2d3e8
    s_mov_b32 s86, 1.0
    s_mov_b32 s87, 1.0
    s_mov_b32 s56, 0
    s_mov_b32 s57, 25165824
    v_lshrrev_b32 v168, 4, v15
    v_bfe_u32 v169, v15, 2, 2
    v_and_b32 v170, 1, v168
    v_lshl_add_u32 v170, v170, 2, v169
    v_and_b32 v169, 6, v170
    s_lshl_b32 s54, s46, 1
    v_xor_b32 v169, s54, v169
    v_bfe_u32 v16, v15, 1, 1
    v_or_b32 v169, v169, v16
    v_lshlrev_b32 v169, 4, v169
    v_lshl_add_u32 v169, v170, 7, v169
    v_lshrrev_b32 v168, 1, v168
    v_mul_u32_u24 v168, 3072, v168
    v_add_u32 v169, v169, v168
    v_and_b32 v168, 1, v15
    v_lshl_add_u32 v16, v168, 3, v169
    v_add_u32 v17, 0x10000, v16
    v_add_u32 v18, 73728, v1
    v_add_u32 v19, 139264, v1
    v_mov_b32 v164, 0x3f803f80
    v_mov_b32 v40, 0
    v_mov_b32 v41, 0
    v_mov_b32 v42, 0
    v_mov_b32 v43, 0
    v_mov_b32 v44, 0
    v_mov_b32 v45, 0
    v_mov_b32 v46, 0
    v_mov_b32 v47, 0
    v_mov_b32 v48, 0
    v_mov_b32 v49, 0
    v_mov_b32 v50, 0
    v_mov_b32 v51, 0
    v_mov_b32 v52, 0
    v_mov_b32 v53, 0
    v_mov_b32 v54, 0
    v_mov_b32 v55, 0
    v_mov_b32 v56, 0
    v_mov_b32 v57, 0
    v_mov_b32 v58, 0
    v_mov_b32 v59, 0
    v_mov_b32 v60, 0
    v_mov_b32 v61, 0
    v_mov_b32 v62, 0
    v_mov_b32 v63, 0
    v_mov_b32 v64, 0
    v_mov_b32 v65, 0
    v_mov_b32 v66, 0
    v_mov_b32 v67, 0
    v_mov_b32 v68, 0
    v_mov_b32 v69, 0
    v_mov_b32 v70, 0
    v_mov_b32 v71, 0
    v_mov_b32 v72, 0
    v_mov_b32 v73, 0
    v_mov_b32 v74, 0
    v_mov_b32 v75, 0
    v_mov_b32 v76, 0
    v_mov_b32 v77, 0
    v_mov_b32 v78, 0
    v_mov_b32 v79, 0
    v_mov_b32 v80, 0
    v_mov_b32 v81, 0
    v_mov_b32 v82, 0
    v_mov_b32 v83, 0
    v_mov_b32 v84, 0
    v_mov_b32 v85, 0
    v_mov_b32 v86, 0
    v_mov_b32 v87, 0
    v_mov_b32 v88, 0
    v_mov_b32 v89, 0
    v_mov_b32 v90, 0
    v_mov_b32 v91, 0
    v_mov_b32 v92, 0
    v_mov_b32 v93, 0
    v_mov_b32 v94, 0
    v_mov_b32 v95, 0
    v_mov_b32 v96, 0
    v_mov_b32 v97, 0
    v_mov_b32 v98, 0
    v_mov_b32 v99, 0
    v_and_b32 v166, 15, v15
    v_lshlrev_b32 v166, 6, v166
    v_lshrrev_b32 v168, 4, v15
    v_lshl_add_u32 v166, v168, 4, v166
    v_and_b32 v168, 1, v15
    v_cmp_eq_u32 vcc, 0, v168
    v_mov_b32 v169, 0xff61b1e6
    s_nop 0
    v_cndmask_b32 v230, v169, 0, vcc
    v_cndmask_b32 v231, 0, v169, vcc
    v_mov_b32 v232, v230
    v_mov_b32 v233, v231
    s_cmp_eq_u32 s44, 0
    s_cselect_b32 s54, 0xff61b1e6, 0
    v_mov_b32 v168, s54
    v_cndmask_b32 v168, v168, 0, s[64:65]
    v_min_f32 v234, v168, v230
    v_mov_b32 v168, s54
    v_cndmask_b32 v168, v168, 0, s[66:67]
    v_min_f32 v235, v168, v231
    v_mov_b32 v168, s54
    v_cndmask_b32 v168, v168, 0, s[68:69]
    v_min_f32 v236, v168, v232
    v_mov_b32 v168, s54
    v_cndmask_b32 v168, v168, 0, s[70:71]
    v_min_f32 v237, v168, v233
    s_lshl_b32 s54, s63, 14
    s_lshl_b32 s55, s45, 11
    s_add_u32 s54, s54, s55
    s_add_u32 s54, s54, s56
    v_mov_b32 v244, 0
    v_mov_b32 v245, 0
    v_mov_b32 v246, 0
    v_mov_b32 v247, 0
    s_waitcnt vmcnt(3)
    v_dot2c_f32_bf16 v244, s62, v2
    v_dot2c_f32_bf16 v246, v2, v2
    v_dot2c_f32_bf16 v245, s62, v3
    v_dot2c_f32_bf16 v247, v3, v3
    s_waitcnt vmcnt(2)
    v_dot2c_f32_bf16 v244, s62, v4
    v_dot2c_f32_bf16 v246, v4, v4
    v_dot2c_f32_bf16 v245, s62, v5
    v_dot2c_f32_bf16 v247, v5, v5
    s_waitcnt vmcnt(1)
    v_dot2c_f32_bf16 v244, s62, v6
    v_dot2c_f32_bf16 v246, v6, v6
    v_dot2c_f32_bf16 v245, s62, v7
    v_dot2c_f32_bf16 v247, v7, v7
    s_waitcnt vmcnt(0)
    v_dot2c_f32_bf16 v244, s62, v8
    v_dot2c_f32_bf16 v246, v8, v8
    v_dot2c_f32_bf16 v245, s62, v9
    v_dot2c_f32_bf16 v247, v9, v9
    v_lshlrev_b32 v240, 6, v15
    s_lshl_b32 s54, s63, 10
    s_lshl_b32 s55, s45, 3
    v_add_f32 v244, v244, v245
    v_add_f32 v245, v246, v247
    s_add_u32 s54, s54, s55
    s_add_u32 s54, s54, s57
    v_mov_b32 v242, v244
    v_mov_b32 v243, v245
    s_nop 0
    v_permlane16_swap_b32 v244, v242
    v_permlane16_swap_b32 v245, v243
    v_add_f32 v244, v244, v242
    v_add_f32 v245, v245, v243
    v_mov_b32 v242, v244
    v_mov_b32 v243, v245
    s_nop 0
    v_permlane32_swap_b32 v244, v242
    v_permlane32_swap_b32 v245, v243
    v_add_f32 v244, v244, v242
    v_add_f32 v245, v245, v243
    s_mov_b64 exec, s[78:79]
    s_nop 7
    s_cmp_eq_u32 s99, 0
    s_cbranch_scc1 L_slow_9
    buffer_store_dwordx2 v[244:245], v240, s[8:11], s54 offen
    s_branch L_join_10
L_slow_9:
    buffer_store_dwordx2 v[244:245], v240, s[8:11], s54 offen sc1
L_join_10:
    s_nop 1
    s_mov_b64 exec, -1
    s_cmp_eq_u32 s101, 0
    s_cbranch_scc1 L_nohc_11
    s_lshr_b32 s54, s44, 2
    s_lshl_b32 s55, s54, 14
    s_lshl_b32 s56, s45, 11
    s_add_u32 s55, s55, s56
    s_add_u32 s55, s55, 26345472
    s_lshl_b32 s55, s54, 10
    s_lshl_b32 s56, s45, 3
    s_add_u32 s55, s55, s56
    s_add_u32 s55, s55, 26607616
    s_mov_b64 exec, s[78:79]
    buffer_store_dwordx2 v[244:245], v240, s[8:11], s55 offen sc1
    s_mov_b64 exec, -1
L_nohc_11:
    s_nop 1
    s_mov_b32 s83, 0
L_cn_12:
    buffer_load_dword v249, v248, s[40:43], 0 offen sc1
    s_waitcnt vmcnt(0)
    v_readfirstlane_b32 s47, v249
    s_nop 3
    s_cmp_lg_u32 s47, 0
    s_cbranch_scc1 L_cnd_13
    s_add_u32 s83, s83, 1
    s_cmp_lt_u32 s83, 200000
    s_cbranch_scc1 L_cn_12
L_cnd_13:
    s_lshl_b32 s54, s44, 3
    s_add_u32 s54, s54, s45
    s_lshl_b32 s54, s54, 2
    s_add_u32 s54, s54, s46
    s_lshl_b32 s54, s54, 2
    s_add_u32 s54, s54, 26296320
    s_or_b32 s55, s47, s100
    v_mov_b32 v249, s55
    s_mov_b64 exec, 1
    buffer_store_dword v249, v248, s[8:11], s54 offen sc1
    s_mov_b64 exec, -1
L_layer:
    s_nop 3
    s_cmp_lg_u32 s46, 1
    s_cbranch_scc1 L_ntch1_14
    v_lshrrev_b32 v240, 4, v15
    v_lshlrev_b32 v240, 14, v240
    v_and_b32 v241, 15, v15
    v_lshl_add_u32 v240, v241, 7, v240
    s_lshl_b32 s54, s44, 16
    s_lshl_b32 s55, s45, 11
    s_add_u32 s54, s54, s55
    s_add_u32 s54, s54, s49
    s_add_u32 s54, s54, 8388608
    buffer_load_dword v241, v240, s[8:11], s54 offen
    v_lshrrev_b32 v242, 5, v15
    v_lshlrev_b32 v242, 15, v242
    v_and_b32 v243, 31, v15
    v_lshl_add_u32 v242, v243, 7, v242
    s_lshl_b32 s54, s44, 16
    s_lshl_b32 s55, s45, 12
    s_add_u32 s54, s54, s55
    s_add_u32 s54, s54, s49
    s_add_u32 s54, s54, 4194304
    buffer_load_dword v243, v242, s[8:11], s54 offen
    v_and_b32 v244, 31, v15
    v_lshlrev_b32 v244, 7, v244
    s_lshl_b32 s54, s44, 12
    s_add_u32 s54, s54, s51
    s_add_u32 s54, s54, 25427968
    buffer_load_dword v245, v244, s[8:11], s54 offen
L_ntch1_14:
    s_nop 1
    s_barrier
    s_barrier
    ds_read_b64_tr_b16 v[144:145], v16 offset:1024
    ds_read_b64_tr_b16 v[146:147], v16 offset:7168
    ds_read_b128 v[104:107], v18 offset:1024
    ds_read_b64_tr_b16 v[148:149], v16 offset:2048
    ds_read_b64_tr_b16 v[150:151], v16 offset:8192
    ds_read_b64_tr_b16 v[140:141], v16 offset:0
    ds_read_b64_tr_b16 v[142:143], v16 offset:6144
    ds_read_b128 v[100:103], v18 offset:0
    ds_read_b128 v[108:111], v18 offset:2048
    ds_read_b128 v[112:115], v18 offset:3072
    ds_read_b128 v[116:119], v18 offset:4096
    s_waitcnt lgkmcnt(3)
    v_mfma_f32_16x16x32_bf16 v[64:67], v[144:147], v[104:107], v[64:67]
    ds_read_b64_tr_b16 v[156:157], v16 offset:13312
    v_mfma_f32_16x16x32_bf16 v[84:87], v[104:107], v[148:151], v[84:87]
    ds_read_b64_tr_b16 v[158:159], v16 offset:19456
    v_mfma_f32_16x16x32_bf16 v[44:47], v[140:143], v[104:107], v[44:47]
    ds_read_b128 v[124:127], v18 offset:6144
    s_waitcnt lgkmcnt(3)
    v_mfma_f32_16x16x32_bf16 v[68:71], v[144:147], v[108:111], v[68:71]
    ds_read_b64_tr_b16 v[160:161], v16 offset:14336
    v_mfma_f32_16x16x32_bf16 v[88:91], v[108:111], v[148:151], v[88:91]
    ds_read_b64_tr_b16 v[162:163], v16 offset:20480
    v_mfma_f32_16x16x32_bf16 v[48:51], v[140:143], v[108:111], v[48:51]
    ds_read_b64_tr_b16 v[152:153], v16 offset:12288
    v_mfma_f32_16x16x32_bf16 v[72:75], v[144:147], v[112:115], v[72:75]
    ds_read_b64_tr_b16 v[154:155], v16 offset:18432
    v_mfma_f32_16x16x32_bf16 v[92:95], v[112:115], v[148:151], v[92:95]
    ds_read_b128 v[120:123], v18 offset:5120
    v_mfma_f32_16x16x32_bf16 v[52:55], v[140:143], v[112:115], v[52:55]
    ds_read_b128 v[128:131], v18 offset:7168
    v_mfma_f32_16x16x32_bf16 v[76:79], v[144:147], v[116:119], v[76:79]
    ds_read_b128 v[132:135], v18 offset:8192
    v_mfma_f32_16x16x32_bf16 v[96:99], v[116:119], v[148:151], v[96:99]
    ds_read_b128 v[136:139], v18 offset:9216
    v_mfma_f32_16x16x32_bf16 v[56:59], v[140:143], v[116:119], v[56:59]
    v_mfma_f32_16x16x32_bf16 v[60:63], v[144:147], v[100:103], v[60:63]
    v_mfma_f32_16x16x32_bf16 v[80:83], v[100:103], v[148:151], v[80:83]
    v_mfma_f32_16x16x32_bf16 v[40:43], v[140:143], v[100:103], v[40:43]
    s_waitcnt lgkmcnt(0)
    s_barrier
    v_mfma_f32_16x16x32_bf16 v[64:67], v[156:159], v[124:127], v[64:67]
    ds_read_b64_tr_b16 v[144:145], v16 offset:25600
    v_mfma_f32_16x16x32_bf16 v[84:87], v[124:127], v[160:163], v[84:87]
    ds_read_b64_tr_b16 v[146:147], v16 offset:31744
    v_mfma_f32_16x16x32_bf16 v[44:47], v[152:155], v[124:127], v[44:47]
    ds_read_b128 v[104:107], v18 offset:11264
    v_mfma_f32_16x16x32_bf16 v[68:71], v[156:159], v[128:131], v[68:71]
    ds_read_b64_tr_b16 v[148:149], v16 offset:26624
    v_mfma_f32_16x16x32_bf16 v[88:91], v[128:131], v[160:163], v[88:91]
    ds_read_b64_tr_b16 v[150:151], v16 offset:32768
    v_mfma_f32_16x16x32_bf16 v[48:51], v[152:155], v[128:131], v[48:51]
    ds_read_b64_tr_b16 v[140:141], v16 offset:24576
    v_mfma_f32_16x16x32_bf16 v[72:75], v[156:159], v[132:135], v[72:75]
    ds_read_b64_tr_b16 v[142:143], v16 offset:30720
    v_mfma_f32_16x16x32_bf16 v[92:95], v[132:135], v[160:163], v[92:95]
    ds_read_b128 v[100:103], v18 offset:10240
    v_mfma_f32_16x16x32_bf16 v[52:55], v[152:155], v[132:135], v[52:55]
    ds_read_b128 v[108:111], v18 offset:12288
    v_mfma_f32_16x16x32_bf16 v[76:79], v[156:159], v[136:139], v[76:79]
    ds_read_b128 v[112:115], v18 offset:13312
    v_mfma_f32_16x16x32_bf16 v[96:99], v[136:139], v[160:163], v[96:99]
    ds_read_b128 v[116:119], v18 offset:14336
    v_mfma_f32_16x16x32_bf16 v[56:59], v[152:155], v[136:139], v[56:59]
    v_mfma_f32_16x16x32_bf16 v[60:63], v[156:159], v[120:123], v[60:63]
    v_mfma_f32_16x16x32_bf16 v[80:83], v[120:123], v[160:163], v[80:83]
    v_mfma_f32_16x16x32_bf16 v[40:43], v[152:155], v[120:123], v[40:43]
    s_waitcnt lgkmcnt(3)
    v_mfma_f32_16x16x32_bf16 v[64:67], v[144:147], v[104:107], v[64:67]
    ds_read_b64_tr_b16 v[156:157], v16 offset:37888
    v_mfma_f32_16x16x32_bf16 v[84:87], v[104:107], v[148:151], v[84:87]
    ds_read_b64_tr_b16 v[158:159], v16 offset:44032
    v_mfma_f32_16x16x32_bf16 v[44:47], v[140:143], v[104:107], v[44:47]
    ds_read_b128 v[124:127], v18 offset:16384
    s_waitcnt lgkmcnt(3)
    v_mfma_f32_16x16x32_bf16 v[68:71], v[144:147], v[108:111], v[68:71]
    ds_read_b64_tr_b16 v[160:161], v16 offset:38912
    v_mfma_f32_16x16x32_bf16 v[88:91], v[108:111], v[148:151], v[88:91]
    ds_read_b64_tr_b16 v[162:163], v16 offset:45056
    v_mfma_f32_16x16x32_bf16 v[48:51], v[140:143], v[108:111], v[48:51]
    ds_read_b64_tr_b16 v[152:153], v16 offset:36864
    v_mfma_f32_16x16x32_bf16 v[72:75], v[144:147], v[112:115], v[72:75]
    ds_read_b64_tr_b16 v[154:155], v16 offset:43008
    v_mfma_f32_16x16x32_bf16 v[92:95], v[112:115], v[148:151], v[92:95]
    ds_read_b128 v[120:123], v18 offset:15360
    v_mfma_f32_16x16x32_bf16 v[52:55], v[140:143], v[112:115], v[52:55]
    ds_read_b128 v[128:131], v18 offset:17408
    v_mfma_f32_16x16x32_bf16 v[76:79], v[144:147], v[116:119], v[76:79]
    ds_read_b128 v[132:135], v18 offset:18432
    v_mfma_f32_16x16x32_bf16 v[96:99], v[116:119], v[148:151], v[96:99]
    ds_read_b128 v[136:139], v18 offset:19456
    v_mfma_f32_16x16x32_bf16 v[56:59], v[140:143], v[116:119], v[56:59]
    v_mfma_f32_16x16x32_bf16 v[60:63], v[144:147], v[100:103], v[60:63]
    v_mfma_f32_16x16x32_bf16 v[80:83], v[100:103], v[148:151], v[80:83]
    v_mfma_f32_16x16x32_bf16 v[40:43], v[140:143], v[100:103], v[40:43]
    s_waitcnt lgkmcnt(0)
    s_barrier
    v_mfma_f32_16x16x32_bf16 v[64:67], v[156:159], v[124:127], v[64:67]
    ds_read_b64_tr_b16 v[144:145], v16 offset:50176
    v_mfma_f32_16x16x32_bf16 v[84:87], v[124:127], v[160:163], v[84:87]
    ds_read_b64_tr_b16 v[146:147], v16 offset:56320
    v_mfma_f32_16x16x32_bf16 v[44:47], v[152:155], v[124:127], v[44:47]
    ds_read_b128 v[104:107], v18 offset:21504
    v_mfma_f32_16x16x32_bf16 v[68:71], v[156:159], v[128:131], v[68:71]
    ds_read_b64_tr_b16 v[148:149], v16 offset:51200
    v_mfma_f32_16x16x32_bf16 v[88:91], v[128:131], v[160:163], v[88:91]
    ds_read_b64_tr_b16 v[150:151], v16 offset:57344
    v_mfma_f32_16x16x32_bf16 v[48:51], v[152:155], v[128:131], v[48:51]
    ds_read_b64_tr_b16 v[140:141], v16 offset:49152
    v_mfma_f32_16x16x32_bf16 v[72:75], v[156:159], v[132:135], v[72:75]
    ds_read_b64_tr_b16 v[142:143], v16 offset:55296
    v_mfma_f32_16x16x32_bf16 v[92:95], v[132:135], v[160:163], v[92:95]
    ds_read_b128 v[100:103], v18 offset:20480
    v_mfma_f32_16x16x32_bf16 v[52:55], v[152:155], v[132:135], v[52:55]
    ds_read_b128 v[108:111], v18 offset:22528
    v_mfma_f32_16x16x32_bf16 v[76:79], v[156:159], v[136:139], v[76:79]
    ds_read_b128 v[112:115], v18 offset:23552
    v_mfma_f32_16x16x32_bf16 v[96:99], v[136:139], v[160:163], v[96:99]
    ds_read_b128 v[116:119], v18 offset:24576
    v_mfma_f32_16x16x32_bf16 v[56:59], v[152:155], v[136:139], v[56:59]
    v_mfma_f32_16x16x32_bf16 v[60:63], v[156:159], v[120:123], v[60:63]
    v_mfma_f32_16x16x32_bf16 v[80:83], v[120:123], v[160:163], v[80:83]
    v_mfma_f32_16x16x32_bf16 v[40:43], v[152:155], v[120:123], v[40:43]
    s_waitcnt lgkmcnt(3)
    v_mfma_f32_16x16x32_bf16 v[64:67], v[144:147], v[104:107], v[64:67]
    ds_read_b64_tr_b16 v[156:157], v16 offset:62464
    v_mfma_f32_16x16x32_bf16 v[84:87], v[104:107], v[148:151], v[84:87]
    ds_read_b64_tr_b16 v[158:159], v17 offset:3072
    v_mfma_f32_16x16x32_bf16 v[44:47], v[140:143], v[104:107], v[44:47]
    ds_read_b128 v[124:127], v18 offset:26624
    s_waitcnt lgkmcnt(3)
    v_mfma_f32_16x16x32_bf16 v[68:71], v[144:147], v[108:111], v[68:71]
    ds_read_b64_tr_b16 v[160:161], v16 offset:63488
    v_mfma_f32_16x16x32_bf16 v[88:91], v[108:111], v[148:151], v[88:91]
    ds_read_b64_tr_b16 v[162:163], v17 offset:4096
    v_mfma_f32_16x16x32_bf16 v[48:51], v[140:143], v[108:111], v[48:51]
    ds_read_b64_tr_b16 v[152:153], v16 offset:61440
    v_mfma_f32_16x16x32_bf16 v[72:75], v[144:147], v[112:115], v[72:75]
    ds_read_b64_tr_b16 v[154:155], v17 offset:2048
    v_mfma_f32_16x16x32_bf16 v[92:95], v[112:115], v[148:151], v[92:95]
    ds_read_b128 v[120:123], v18 offset:25600
    v_mfma_f32_16x16x32_bf16 v[52:55], v[140:143], v[112:115], v[52:55]
    ds_read_b128 v[128:131], v18 offset:27648
    v_mfma_f32_16x16x32_bf16 v[76:79], v[144:147], v[116:119], v[76:79]
    ds_read_b128 v[132:135], v18 offset:28672
    v_mfma_f32_16x16x32_bf16 v[96:99], v[116:119], v[148:151], v[96:99]
    ds_read_b128 v[136:139], v18 offset:29696
    v_mfma_f32_16x16x32_bf16 v[56:59], v[140:143], v[116:119], v[56:59]
    v_mfma_f32_16x16x32_bf16 v[60:63], v[144:147], v[100:103], v[60:63]
    v_mfma_f32_16x16x32_bf16 v[80:83], v[100:103], v[148:151], v[80:83]
    v_mfma_f32_16x16x32_bf16 v[40:43], v[140:143], v[100:103], v[40:43]
    s_waitcnt lgkmcnt(0)
    s_barrier
    v_mfma_f32_16x16x32_bf16 v[64:67], v[156:159], v[124:127], v[64:67]
    ds_read_b64_tr_b16 v[144:145], v16 offset:1024
    v_mfma_f32_16x16x32_bf16 v[84:87], v[124:127], v[160:163], v[84:87]
    ds_read_b64_tr_b16 v[146:147], v16 offset:7168
    v_mfma_f32_16x16x32_bf16 v[44:47], v[152:155], v[124:127], v[44:47]
    ds_read_b128 v[104:107], v18 offset:31744
    v_mfma_f32_16x16x32_bf16 v[68:71], v[156:159], v[128:131], v[68:71]
    ds_read_b64_tr_b16 v[148:149], v16 offset:2048
    v_mfma_f32_16x16x32_bf16 v[88:91], v[128:131], v[160:163], v[88:91]
    ds_read_b64_tr_b16 v[150:151], v16 offset:8192
    v_mfma_f32_16x16x32_bf16 v[48:51], v[152:155], v[128:131], v[48:51]
    ds_read_b64_tr_b16 v[140:141], v16 offset:0
    v_mfma_f32_16x16x32_bf16 v[72:75], v[156:159], v[132:135], v[72:75]
    ds_read_b64_tr_b16 v[142:143], v16 offset:6144
    v_mfma_f32_16x16x32_bf16 v[92:95], v[132:135], v[160:163], v[92:95]
    ds_read_b128 v[100:103], v18 offset:30720
    v_mfma_f32_16x16x32_bf16 v[52:55], v[152:155], v[132:135], v[52:55]
    ds_read_b128 v[108:111], v18 offset:32768
    v_mfma_f32_16x16x32_bf16 v[76:79], v[156:159], v[136:139], v[76:79]
    ds_read_b128 v[112:115], v18 offset:33792
    v_mfma_f32_16x16x32_bf16 v[96:99], v[136:139], v[160:163], v[96:99]
    ds_read_b128 v[116:119], v18 offset:34816
    v_mfma_f32_16x16x32_bf16 v[56:59], v[152:155], v[136:139], v[56:59]
    v_mfma_f32_16x16x32_bf16 v[60:63], v[156:159], v[120:123], v[60:63]
    v_mfma_f32_16x16x32_bf16 v[80:83], v[120:123], v[160:163], v[80:83]
    v_mfma_f32_16x16x32_bf16 v[40:43], v[152:155], v[120:123], v[40:43]
    s_waitcnt lgkmcnt(3)
    v_mfma_f32_16x16x32_bf16 v[64:67], v[144:147], v[104:107], v[64:67]
    ds_read_b64_tr_b16 v[156:157], v16 offset:13312
    v_mfma_f32_16x16x32_bf16 v[84:87], v[104:107], v[148:151], v[84:87]
    ds_read_b64_tr_b16 v[158:159], v16 offset:19456
    v_mfma_f32_16x16x32_bf16 v[44:47], v[140:143], v[104:107], v[44:47]
    ds_read_b128 v[124:127], v18 offset:36864
    s_waitcnt lgkmcnt(3)
    v_mfma_f32_16x16x32_bf16 v[68:71], v[144:147], v[108:111], v[68:71]
    ds_read_b64_tr_b16 v[160:161], v16 offset:14336
    v_mfma_f32_16x16x32_bf16 v[88:91], v[108:111], v[148:151], v[88:91]
    ds_read_b64_tr_b16 v[162:163], v16 offset:20480
    v_mfma_f32_16x16x32_bf16 v[48:51], v[140:143], v[108:111], v[48:51]
    ds_read_b64_tr_b16 v[152:153], v16 offset:12288
    v_mfma_f32_16x16x32_bf16 v[72:75], v[144:147], v[112:115], v[72:75]
    ds_read_b64_tr_b16 v[154:155], v16 offset:18432
    v_mfma_f32_16x16x32_bf16 v[92:95], v[112:115], v[148:151], v[92:95]
    ds_read_b128 v[120:123], v18 offset:35840
    v_mfma_f32_16x16x32_bf16 v[52:55], v[140:143], v[112:115], v[52:55]
    ds_read_b128 v[128:131], v18 offset:37888
    v_mfma_f32_16x16x32_bf16 v[76:79], v[144:147], v[116:119], v[76:79]
    ds_read_b128 v[132:135], v18 offset:38912
    v_mfma_f32_16x16x32_bf16 v[96:99], v[116:119], v[148:151], v[96:99]
    ds_read_b128 v[136:139], v18 offset:39936
    v_mfma_f32_16x16x32_bf16 v[56:59], v[140:143], v[116:119], v[56:59]
    v_mfma_f32_16x16x32_bf16 v[60:63], v[144:147], v[100:103], v[60:63]
    v_mfma_f32_16x16x32_bf16 v[80:83], v[100:103], v[148:151], v[80:83]
    v_mfma_f32_16x16x32_bf16 v[40:43], v[140:143], v[100:103], v[40:43]
    s_waitcnt lgkmcnt(0)
    s_barrier
    v_mfma_f32_16x16x32_bf16 v[64:67], v[156:159], v[124:127], v[64:67]
    ds_read_b64_tr_b16 v[144:145], v16 offset:25600
    v_mfma_f32_16x16x32_bf16 v[84:87], v[124:127], v[160:163], v[84:87]
    ds_read_b64_tr_b16 v[146:147], v16 offset:31744
    v_mfma_f32_16x16x32_bf16 v[44:47], v[152:155], v[124:127], v[44:47]
    ds_read_b128 v[104:107], v18 offset:41984
    v_mfma_f32_16x16x32_bf16 v[68:71], v[156:159], v[128:131], v[68:71]
    ds_read_b64_tr_b16 v[148:149], v16 offset:26624
    v_mfma_f32_16x16x32_bf16 v[88:91], v[128:131], v[160:163], v[88:91]
    ds_read_b64_tr_b16 v[150:151], v16 offset:32768
    v_mfma_f32_16x16x32_bf16 v[48:51], v[152:155], v[128:131], v[48:51]
    ds_read_b64_tr_b16 v[140:141], v16 offset:24576
    v_mfma_f32_16x16x32_bf16 v[72:75], v[156:159], v[132:135], v[72:75]
    ds_read_b64_tr_b16 v[142:143], v16 offset:30720
    v_mfma_f32_16x16x32_bf16 v[92:95], v[132:135], v[160:163], v[92:95]
    ds_read_b128 v[100:103], v18 offset:40960
    v_mfma_f32_16x16x32_bf16 v[52:55], v[152:155], v[132:135], v[52:55]
    ds_read_b128 v[108:111], v18 offset:43008
    v_mfma_f32_16x16x32_bf16 v[76:79], v[156:159], v[136:139], v[76:79]
    ds_read_b128 v[112:115], v18 offset:44032
    v_mfma_f32_16x16x32_bf16 v[96:99], v[136:139], v[160:163], v[96:99]
    ds_read_b128 v[116:119], v18 offset:45056
    v_mfma_f32_16x16x32_bf16 v[56:59], v[152:155], v[136:139], v[56:59]
    v_mfma_f32_16x16x32_bf16 v[60:63], v[156:159], v[120:123], v[60:63]
    v_mfma_f32_16x16x32_bf16 v[80:83], v[120:123], v[160:163], v[80:83]
    v_mfma_f32_16x16x32_bf16 v[40:43], v[152:155], v[120:123], v[40:43]
    s_waitcnt lgkmcnt(3)
    v_mfma_f32_16x16x32_bf16 v[64:67], v[144:147], v[104:107], v[64:67]
    ds_read_b64_tr_b16 v[156:157], v16 offset:37888
    v_mfma_f32_16x16x32_bf16 v[84:87], v[104:107], v[148:151], v[84:87]
    ds_read_b64_tr_b16 v[158:159], v16 offset:44032
    v_mfma_f32_16x16x32_bf16 v[44:47], v[140:143], v[104:107], v[44:47]
    ds_read_b128 v[124:127], v18 offset:47104
    s_waitcnt lgkmcnt(3)
    v_mfma_f32_16x16x32_bf16 v[68:71], v[144:147], v[108:111], v[68:71]
    ds_read_b64_tr_b16 v[160:161], v16 offset:38912
    v_mfma_f32_16x16x32_bf16 v[88:91], v[108:111], v[148:151], v[88:91]
    ds_read_b64_tr_b16 v[162:163], v16 offset:45056
    v_mfma_f32_16x16x32_bf16 v[48:51], v[140:143], v[108:111], v[48:51]
    ds_read_b64_tr_b16 v[152:153], v16 offset:36864
    v_mfma_f32_16x16x32_bf16 v[72:75], v[144:147], v[112:115], v[72:75]
    ds_read_b64_tr_b16 v[154:155], v16 offset:43008
    v_mfma_f32_16x16x32_bf16 v[92:95], v[112:115], v[148:151], v[92:95]
    ds_read_b128 v[120:123], v18 offset:46080
    v_mfma_f32_16x16x32_bf16 v[52:55], v[140:143], v[112:115], v[52:55]
    ds_read_b128 v[128:131], v18 offset:48128
    v_mfma_f32_16x16x32_bf16 v[76:79], v[144:147], v[116:119], v[76:79]
    ds_read_b128 v[132:135], v18 offset:49152
    v_mfma_f32_16x16x32_bf16 v[96:99], v[116:119], v[148:151], v[96:99]
    ds_read_b128 v[136:139], v18 offset:50176
    v_mfma_f32_16x16x32_bf16 v[56:59], v[140:143], v[116:119], v[56:59]
    v_mfma_f32_16x16x32_bf16 v[60:63], v[144:147], v[100:103], v[60:63]
    v_mfma_f32_16x16x32_bf16 v[80:83], v[100:103], v[148:151], v[80:83]
    v_mfma_f32_16x16x32_bf16 v[40:43], v[140:143], v[100:103], v[40:43]
    s_waitcnt lgkmcnt(0)
    s_barrier
    v_mfma_f32_16x16x32_bf16 v[64:67], v[156:159], v[124:127], v[64:67]
    ds_read_b64_tr_b16 v[144:145], v16 offset:50176
    v_mfma_f32_16x16x32_bf16 v[84:87], v[124:127], v[160:163], v[84:87]
    ds_read_b64_tr_b16 v[146:147], v16 offset:56320
    v_mfma_f32_16x16x32_bf16 v[44:47], v[152:155], v[124:127], v[44:47]
    ds_read_b128 v[104:107], v18 offset:52224
    v_mfma_f32_16x16x32_bf16 v[68:71], v[156:159], v[128:131], v[68:71]
    ds_read_b64_tr_b16 v[148:149], v16 offset:51200
    v_mfma_f32_16x16x32_bf16 v[88:91], v[128:131], v[160:163], v[88:91]
    ds_read_b64_tr_b16 v[150:151], v16 offset:57344
    v_mfma_f32_16x16x32_bf16 v[48:51], v[152:155], v[128:131], v[48:51]
    ds_read_b64_tr_b16 v[140:141], v16 offset:49152
    v_mfma_f32_16x16x32_bf16 v[72:75], v[156:159], v[132:135], v[72:75]
    ds_read_b64_tr_b16 v[142:143], v16 offset:55296
    v_mfma_f32_16x16x32_bf16 v[92:95], v[132:135], v[160:163], v[92:95]
    ds_read_b128 v[100:103], v18 offset:51200
    v_mfma_f32_16x16x32_bf16 v[52:55], v[152:155], v[132:135], v[52:55]
    ds_read_b128 v[108:111], v18 offset:53248
    v_mfma_f32_16x16x32_bf16 v[76:79], v[156:159], v[136:139], v[76:79]
    ds_read_b128 v[112:115], v18 offset:54272
    v_mfma_f32_16x16x32_bf16 v[96:99], v[136:139], v[160:163], v[96:99]
    ds_read_b128 v[116:119], v18 offset:55296
    v_mfma_f32_16x16x32_bf16 v[56:59], v[152:155], v[136:139], v[56:59]
    v_mfma_f32_16x16x32_bf16 v[60:63], v[156:159], v[120:123], v[60:63]
    v_mfma_f32_16x16x32_bf16 v[80:83], v[120:123], v[160:163], v[80:83]
    v_mfma_f32_16x16x32_bf16 v[40:43], v[152:155], v[120:123], v[40:43]
    s_waitcnt lgkmcnt(3)
    v_mfma_f32_16x16x32_bf16 v[64:67], v[144:147], v[104:107], v[64:67]
    ds_read_b64_tr_b16 v[156:157], v16 offset:62464
    v_mfma_f32_16x16x32_bf16 v[84:87], v[104:107], v[148:151], v[84:87]
    ds_read_b64_tr_b16 v[158:159], v17 offset:3072
    v_mfma_f32_16x16x32_bf16 v[44:47], v[140:143], v[104:107], v[44:47]
    ds_read_b128 v[124:127], v18 offset:57344
    s_waitcnt lgkmcnt(3)
    v_mfma_f32_16x16x32_bf16 v[68:71], v[144:147], v[108:111], v[68:71]
    ds_read_b64_tr_b16 v[160:161], v16 offset:63488
    v_mfma_f32_16x16x32_bf16 v[88:91], v[108:111], v[148:151], v[88:91]
    ds_read_b64_tr_b16 v[162:163], v17 offset:4096
    v_mfma_f32_16x16x32_bf16 v[48:51], v[140:143], v[108:111], v[48:51]
    ds_read_b64_tr_b16 v[152:153], v16 offset:61440
    v_mfma_f32_16x16x32_bf16 v[72:75], v[144:147], v[112:115], v[72:75]
    ds_read_b64_tr_b16 v[154:155], v17 offset:2048
    v_mfma_f32_16x16x32_bf16 v[92:95], v[112:115], v[148:151], v[92:95]
    ds_read_b128 v[120:123], v18 offset:56320
    v_mfma_f32_16x16x32_bf16 v[52:55], v[140:143], v[112:115], v[52:55]
    ds_read_b128 v[128:131], v18 offset:58368
    v_mfma_f32_16x16x32_bf16 v[76:79], v[144:147], v[116:119], v[76:79]
    ds_read_b128 v[132:135], v18 offset:59392
    v_mfma_f32_16x16x32_bf16 v[96:99], v[116:119], v[148:151], v[96:99]
    ds_read_b128 v[136:139], v18 offset:60416
    v_mfma_f32_16x16x32_bf16 v[56:59], v[140:143], v[116:119], v[56:59]
    v_mfma_f32_16x16x32_bf16 v[60:63], v[144:147], v[100:103], v[60:63]
    v_mfma_f32_16x16x32_bf16 v[80:83], v[100:103], v[148:151], v[80:83]
    v_mfma_f32_16x16x32_bf16 v[40:43], v[140:143], v[100:103], v[40:43]
    s_waitcnt lgkmcnt(0)
    s_barrier
    v_mfma_f32_16x16x32_bf16 v[64:67], v[156:159], v[124:127], v[64:67]
    ds_read_b64_tr_b16 v[144:145], v16 offset:1024
    v_mfma_f32_16x16x32_bf16 v[84:87], v[124:127], v[160:163], v[84:87]
    ds_read_b64_tr_b16 v[146:147], v16 offset:7168
    v_mfma_f32_16x16x32_bf16 v[44:47], v[152:155], v[124:127], v[44:47]
    ds_read_b128 v[104:107], v18 offset:62464
    v_mfma_f32_16x16x32_bf16 v[68:71], v[156:159], v[128:131], v[68:71]
    ds_read_b64_tr_b16 v[148:149], v16 offset:2048
    v_mfma_f32_16x16x32_bf16 v[88:91], v[128:131], v[160:163], v[88:91]
    ds_read_b64_tr_b16 v[150:151], v16 offset:8192
    v_mfma_f32_16x16x32_bf16 v[48:51], v[152:155], v[128:131], v[48:51]
    ds_read_b64_tr_b16 v[140:141], v16 offset:0
    v_mfma_f32_16x16x32_bf16 v[72:75], v[156:159], v[132:135], v[72:75]
    ds_read_b64_tr_b16 v[142:143], v16 offset:6144
    v_mfma_f32_16x16x32_bf16 v[92:95], v[132:135], v[160:163], v[92:95]
    ds_read_b128 v[100:103], v18 offset:61440
    v_mfma_f32_16x16x32_bf16 v[52:55], v[152:155], v[132:135], v[52:55]
    ds_read_b128 v[108:111], v18 offset:63488
    v_mfma_f32_16x16x32_bf16 v[76:79], v[156:159], v[136:139], v[76:79]
    ds_read_b128 v[112:115], v18 offset:64512
    v_mfma_f32_16x16x32_bf16 v[96:99], v[136:139], v[160:163], v[96:99]
    ds_read_b128 v[116:119], v19 offset:0
    v_mfma_f32_16x16x32_bf16 v[56:59], v[152:155], v[136:139], v[56:59]
    v_mfma_f32_16x16x32_bf16 v[60:63], v[156:159], v[120:123], v[60:63]
    v_mfma_f32_16x16x32_bf16 v[80:83], v[120:123], v[160:163], v[80:83]
    v_mfma_f32_16x16x32_bf16 v[40:43], v[152:155], v[120:123], v[40:43]
    s_waitcnt lgkmcnt(3)
    v_mfma_f32_16x16x32_bf16 v[64:67], v[144:147], v[104:107], v[64:67]
    ds_read_b64_tr_b16 v[156:157], v16 offset:13312
    v_mfma_f32_16x16x32_bf16 v[84:87], v[104:107], v[148:151], v[84:87]
    ds_read_b64_tr_b16 v[158:159], v16 offset:19456
    v_mfma_f32_16x16x32_bf16 v[44:47], v[140:143], v[104:107], v[44:47]
    ds_read_b128 v[124:127], v19 offset:2048
    s_waitcnt lgkmcnt(3)
    v_mfma_f32_16x16x32_bf16 v[68:71], v[144:147], v[108:111], v[68:71]
    ds_read_b64_tr_b16 v[160:161], v16 offset:14336
    v_mfma_f32_16x16x32_bf16 v[88:91], v[108:111], v[148:151], v[88:91]
    ds_read_b64_tr_b16 v[162:163], v16 offset:20480
    v_mfma_f32_16x16x32_bf16 v[48:51], v[140:143], v[108:111], v[48:51]
    ds_read_b64_tr_b16 v[152:153], v16 offset:12288
    v_mfma_f32_16x16x32_bf16 v[72:75], v[144:147], v[112:115], v[72:75]
    ds_read_b64_tr_b16 v[154:155], v16 offset:18432
    v_mfma_f32_16x16x32_bf16 v[92:95], v[112:115], v[148:151], v[92:95]
    ds_read_b128 v[120:123], v19 offset:1024
    v_mfma_f32_16x16x32_bf16 v[52:55], v[140:143], v[112:115], v[52:55]
    ds_read_b128 v[128:131], v19 offset:3072
    v_mfma_f32_16x16x32_bf16 v[76:79], v[144:147], v[116:119], v[76:79]
    ds_read_b128 v[132:135], v19 offset:4096
    v_mfma_f32_16x16x32_bf16 v[96:99], v[116:119], v[148:151], v[96:99]
    ds_read_b128 v[136:139], v19 offset:5120
    v_mfma_f32_16x16x32_bf16 v[56:59], v[140:143], v[116:119], v[56:59]
    v_mfma_f32_16x16x32_bf16 v[60:63], v[144:147], v[100:103], v[60:63]
    v_mfma_f32_16x16x32_bf16 v[80:83], v[100:103], v[148:151], v[80:83]
    v_mfma_f32_16x16x32_bf16 v[40:43], v[140:143], v[100:103], v[40:43]
    s_waitcnt lgkmcnt(0)
    s_barrier
    v_mfma_f32_16x16x32_bf16 v[64:67], v[156:159], v[124:127], v[64:67]
    ds_read_b64_tr_b16 v[144:145], v16 offset:25600
    v_mfma_f32_16x16x32_bf16 v[84:87], v[124:127], v[160:163], v[84:87]
    ds_read_b64_tr_b16 v[146:147], v16 offset:31744
    v_mfma_f32_16x16x32_bf16 v[44:47], v[152:155], v[124:127], v[44:47]
    ds_read_b128 v[104:107], v19 offset:7168
    v_mfma_f32_16x16x32_bf16 v[68:71], v[156:159], v[128:131], v[68:71]
    ds_read_b64_tr_b16 v[148:149], v16 offset:26624
    v_mfma_f32_16x16x32_bf16 v[88:91], v[128:131], v[160:163], v[88:91]
    ds_read_b64_tr_b16 v[150:151], v16 offset:32768
    v_mfma_f32_16x16x32_bf16 v[48:51], v[152:155], v[128:131], v[48:51]
    ds_read_b64_tr_b16 v[140:141], v16 offset:24576
    v_mfma_f32_16x16x32_bf16 v[72:75], v[156:159], v[132:135], v[72:75]
    ds_read_b64_tr_b16 v[142:143], v16 offset:30720
    v_mfma_f32_16x16x32_bf16 v[92:95], v[132:135], v[160:163], v[92:95]
    ds_read_b128 v[100:103], v19 offset:6144
    v_mfma_f32_16x16x32_bf16 v[52:55], v[152:155], v[132:135], v[52:55]
    ds_read_b128 v[108:111], v19 offset:8192
    v_mfma_f32_16x16x32_bf16 v[76:79], v[156:159], v[136:139], v[76:79]
    ds_read_b128 v[112:115], v19 offset:9216
    v_mfma_f32_16x16x32_bf16 v[96:99], v[136:139], v[160:163], v[96:99]
    ds_read_b128 v[116:119], v19 offset:10240
    v_mfma_f32_16x16x32_bf16 v[56:59], v[152:155], v[136:139], v[56:59]
    v_mfma_f32_16x16x32_bf16 v[60:63], v[156:159], v[120:123], v[60:63]
    v_mfma_f32_16x16x32_bf16 v[80:83], v[120:123], v[160:163], v[80:83]
    v_mfma_f32_16x16x32_bf16 v[40:43], v[152:155], v[120:123], v[40:43]
    s_waitcnt lgkmcnt(3)
    v_mfma_f32_16x16x32_bf16 v[64:67], v[144:147], v[104:107], v[64:67]
    ds_read_b64_tr_b16 v[156:157], v16 offset:37888
    v_mfma_f32_16x16x32_bf16 v[84:87], v[104:107], v[148:151], v[84:87]
    ds_read_b64_tr_b16 v[158:159], v16 offset:44032
    v_mfma_f32_16x16x32_bf16 v[44:47], v[140:143], v[104:107], v[44:47]
    ds_read_b128 v[124:127], v19 offset:12288
    s_waitcnt lgkmcnt(3)
    v_mfma_f32_16x16x32_bf16 v[68:71], v[144:147], v[108:111], v[68:71]
    ds_read_b64_tr_b16 v[160:161], v16 offset:38912
    v_mfma_f32_16x16x32_bf16 v[88:91], v[108:111], v[148:151], v[88:91]
    ds_read_b64_tr_b16 v[162:163], v16 offset:45056
    v_mfma_f32_16x16x32_bf16 v[48:51], v[140:143], v[108:111], v[48:51]
    ds_read_b64_tr_b16 v[152:153], v16 offset:36864
    v_mfma_f32_16x16x32_bf16 v[72:75], v[144:147], v[112:115], v[72:75]
    ds_read_b64_tr_b16 v[154:155], v16 offset:43008
    v_mfma_f32_16x16x32_bf16 v[92:95], v[112:115], v[148:151], v[92:95]
    ds_read_b128 v[120:123], v19 offset:11264
    v_mfma_f32_16x16x32_bf16 v[52:55], v[140:143], v[112:115], v[52:55]
    ds_read_b128 v[128:131], v19 offset:13312
    v_mfma_f32_16x16x32_bf16 v[76:79], v[144:147], v[116:119], v[76:79]
    ds_read_b128 v[132:135], v19 offset:14336
    v_mfma_f32_16x16x32_bf16 v[96:99], v[116:119], v[148:151], v[96:99]
    ds_read_b128 v[136:139], v19 offset:15360
    v_mfma_f32_16x16x32_bf16 v[56:59], v[140:143], v[116:119], v[56:59]
    v_mfma_f32_16x16x32_bf16 v[60:63], v[144:147], v[100:103], v[60:63]
    v_mfma_f32_16x16x32_bf16 v[80:83], v[100:103], v[148:151], v[80:83]
    v_mfma_f32_16x16x32_bf16 v[40:43], v[140:143], v[100:103], v[40:43]
    s_waitcnt lgkmcnt(3)
    v_mfma_f32_16x16x32_bf16 v[64:67], v[156:159], v[124:127], v[64:67]
    v_mfma_f32_16x16x32_bf16 v[84:87], v[124:127], v[160:163], v[84:87]
    v_mfma_f32_16x16x32_bf16 v[44:47], v[152:155], v[124:127], v[44:47]
    s_waitcnt lgkmcnt(0)
    v_mfma_f32_16x16x32_bf16 v[68:71], v[156:159], v[128:131], v[68:71]
    v_mfma_f32_16x16x32_bf16 v[88:91], v[128:131], v[160:163], v[88:91]
    v_mfma_f32_16x16x32_bf16 v[48:51], v[152:155], v[128:131], v[48:51]
    v_mfma_f32_16x16x32_bf16 v[72:75], v[156:159], v[132:135], v[72:75]
    v_mfma_f32_16x16x32_bf16 v[92:95], v[132:135], v[160:163], v[92:95]
    v_mfma_f32_16x16x32_bf16 v[52:55], v[152:155], v[132:135], v[52:55]
    v_mfma_f32_16x16x32_bf16 v[76:79], v[156:159], v[136:139], v[76:79]
    v_mfma_f32_16x16x32_bf16 v[96:99], v[136:139], v[160:163], v[96:99]
    v_mfma_f32_16x16x32_bf16 v[56:59], v[152:155], v[136:139], v[56:59]
    v_mfma_f32_16x16x32_bf16 v[60:63], v[156:159], v[120:123], v[60:63]
    v_mfma_f32_16x16x32_bf16 v[80:83], v[120:123], v[160:163], v[80:83]
    v_mfma_f32_16x16x32_bf16 v[40:43], v[152:155], v[120:123], v[40:43]
    v_and_b32 v168, 15, v15
    v_lshl_add_u32 v168, v168, 2, 0
    v_add_u32 v168, 155648, v168
    v_lshrrev_b32 v169, 4, v15
    v_lshlrev_b32 v169, 4, v169
    v_add_u32 v169, 155648, v169
    ds_read2_b32 v[172:173], v168 offset0:0 offset1:128
    ds_read2_b32 v[174:175], v168 offset0:16 offset1:144
    ds_read2_b32 v[176:177], v168 offset0:32 offset1:160
    ds_read2_b32 v[178:179], v168 offset0:48 offset1:176
    ds_read2_b32 v[180:181], v168 offset0:64 offset1:192
    ds_read_b128 v[190:193], v169 offset:0
    ds_read_b128 v[210:213], v169 offset:512
    ds_read_b128 v[194:197], v169 offset:64
    ds_read_b128 v[214:217], v169 offset:576
    ds_read_b128 v[198:201], v169 offset:128
    ds_read_b128 v[218:221], v169 offset:640
    ds_read_b128 v[202:205], v169 offset:192
    ds_read_b128 v[222:225], v169 offset:704
    ds_read_b128 v[206:209], v169 offset:256
    ds_read_b128 v[226:229], v169 offset:768
    s_waitcnt lgkmcnt(0)
    s_barrier
    v_mov_b32 v252, 159744
    ds_read_b64 v[250:251], v252
    s_waitcnt lgkmcnt(0)
    v_readfirstlane_b32 s99, v250
    v_readfirstlane_b32 s47, v251
    v_mul_f32 v182, 0x3eb8aa3b, v175
    v_mul_f32 v184, 0x3eb8aa3b, v177
    v_mul_f32 v186, 0x3eb8aa3b, v179
    v_mul_f32 v188, 0x3eb8aa3b, v181
    v_mov_b32_dpp v100, v40 row_newbcast:0 row_mask:0xf bank_mask:0xf
    v_mov_b32_dpp v104, v60 row_newbcast:0 row_mask:0xf bank_mask:0xf
    v_mov_b32_dpp v101, v41 row_newbcast:0 row_mask:0xf bank_mask:0xf
    v_mov_b32_dpp v105, v61 row_newbcast:0 row_mask:0xf bank_mask:0xf
    v_mov_b32_dpp v102, v42 row_newbcast:0 row_mask:0xf bank_mask:0xf
    v_mov_b32_dpp v106, v62 row_newbcast:0 row_mask:0xf bank_mask:0xf
    v_mov_b32_dpp v103, v43 row_newbcast:0 row_mask:0xf bank_mask:0xf
    v_mov_b32_dpp v107, v63 row_newbcast:0 row_mask:0xf bank_mask:0xf
    v_mov_b32 v108, v80
    v_mov_b32 v109, v80
    v_pk_fma_f32 v[60:61], v[104:105], v[172:173], v[60:61] op_sel:[0,0,0] op_sel_hi:[1,0,1]
    v_pk_fma_f32 v[62:63], v[106:107], v[172:173], v[62:63] op_sel:[0,0,0] op_sel_hi:[1,0,1]
    v_pk_fma_f32 v[64:65], v[104:105], v[174:175], v[64:65] op_sel:[0,0,0] op_sel_hi:[1,0,1]
    v_pk_fma_f32 v[66:67], v[106:107], v[174:175], v[66:67] op_sel:[0,0,0] op_sel_hi:[1,0,1]
    v_pk_fma_f32 v[68:69], v[104:105], v[176:177], v[68:69] op_sel:[0,0,0] op_sel_hi:[1,0,1]
    v_pk_fma_f32 v[70:71], v[106:107], v[176:177], v[70:71] op_sel:[0,0,0] op_sel_hi:[1,0,1]
    v_pk_fma_f32 v[72:73], v[104:105], v[178:179], v[72:73] op_sel:[0,0,0] op_sel_hi:[1,0,1]
    v_pk_fma_f32 v[74:75], v[106:107], v[178:179], v[74:75] op_sel:[0,0,0] op_sel_hi:[1,0,1]
    v_pk_fma_f32 v[76:77], v[104:105], v[180:181], v[76:77] op_sel:[0,0,0] op_sel_hi:[1,0,1]
    v_pk_fma_f32 v[78:79], v[106:107], v[180:181], v[78:79] op_sel:[0,0,0] op_sel_hi:[1,0,1]
    v_permlane16_swap_b32 v108, v109
    v_pk_fma_f32 v[44:45], v[100:101], v[174:175], v[44:45] op_sel:[0,0,0] op_sel_hi:[1,0,1]
    v_pk_fma_f32 v[46:47], v[102:103], v[174:175], v[46:47] op_sel:[0,0,0] op_sel_hi:[1,0,1]
    v_pk_fma_f32 v[48:49], v[100:101], v[176:177], v[48:49] op_sel:[0,0,0] op_sel_hi:[1,0,1]
    v_pk_fma_f32 v[50:51], v[102:103], v[176:177], v[50:51] op_sel:[0,0,0] op_sel_hi:[1,0,1]
    v_pk_fma_f32 v[52:53], v[100:101], v[178:179], v[52:53] op_sel:[0,0,0] op_sel_hi:[1,0,1]
    v_pk_fma_f32 v[54:55], v[102:103], v[178:179], v[54:55] op_sel:[0,0,0] op_sel_hi:[1,0,1]
    v_pk_fma_f32 v[56:57], v[100:101], v[180:181], v[56:57] op_sel:[0,0,0] op_sel_hi:[1,0,1]
    v_pk_fma_f32 v[58:59], v[102:103], v[180:181], v[58:59] op_sel:[0,0,0] op_sel_hi:[1,0,1]
    v_mov_b32 v109, v108
    v_pk_mul_f32 v[60:61], v[60:61], v[172:173] op_sel:[0,1] op_sel_hi:[1,1]
    v_pk_mul_f32 v[62:63], v[62:63], v[172:173] op_sel:[0,1] op_sel_hi:[1,1]
    v_pk_mul_f32 v[64:65], v[64:65], v[174:175] op_sel:[0,1] op_sel_hi:[1,1]
    v_pk_mul_f32 v[66:67], v[66:67], v[174:175] op_sel:[0,1] op_sel_hi:[1,1]
    v_pk_mul_f32 v[68:69], v[68:69], v[176:177] op_sel:[0,1] op_sel_hi:[1,1]
    v_pk_mul_f32 v[70:71], v[70:71], v[176:177] op_sel:[0,1] op_sel_hi:[1,1]
    v_pk_mul_f32 v[72:73], v[72:73], v[178:179] op_sel:[0,1] op_sel_hi:[1,1]
    v_pk_mul_f32 v[74:75], v[74:75], v[178:179] op_sel:[0,1] op_sel_hi:[1,1]
    v_pk_mul_f32 v[76:77], v[76:77], v[180:181] op_sel:[0,1] op_sel_hi:[1,1]
    v_pk_mul_f32 v[78:79], v[78:79], v[180:181] op_sel:[0,1] op_sel_hi:[1,1]
    v_permlane32_swap_b32 v108, v109
    v_cvt_pk_bf16_f32 v20, v44, v45
    v_cvt_pk_bf16_f32 v21, v46, v47
    v_cvt_pk_bf16_f32 v22, v48, v49
    v_cvt_pk_bf16_f32 v23, v50, v51
    v_cvt_pk_bf16_f32 v24, v52, v53
    v_cvt_pk_bf16_f32 v25, v54, v55
    v_cvt_pk_bf16_f32 v26, v56, v57
    v_cvt_pk_bf16_f32 v27, v58, v59
    v_cvt_pk_bf16_f32 v30, v60, v61
    v_cvt_pk_bf16_f32 v31, v62, v63
    v_cvt_pk_bf16_f32 v32, v64, v65
    v_cvt_pk_bf16_f32 v33, v66, v67
    v_cvt_pk_bf16_f32 v34, v68, v69
    v_cvt_pk_bf16_f32 v35, v70, v71
    v_cvt_pk_bf16_f32 v36, v72, v73
    v_cvt_pk_bf16_f32 v37, v74, v75
    v_cvt_pk_bf16_f32 v38, v76, v77
    v_cvt_pk_bf16_f32 v39, v78, v79
    v_mfma_f32_16x16x16_bf16 v[44:47], v[30:31], v[20:21], 0
    v_mfma_f32_16x16x16_bf16 v[64:67], v[32:33], v[20:21], 0
    v_mfma_f32_16x16x16_bf16 v[48:51], v[32:33], v[22:23], 0
    v_mfma_f32_16x16x16_bf16 v[68:71], v[34:35], v[22:23], 0
    v_mfma_f32_16x16x16_bf16 v[52:55], v[34:35], v[24:25], 0
    v_mfma_f32_16x16x16_bf16 v[72:75], v[36:37], v[24:25], 0
    v_mfma_f32_16x16x16_bf16 v[56:59], v[36:37], v[26:27], 0
    v_mfma_f32_16x16x16_bf16 v[76:79], v[38:39], v[26:27], 0
    v_pk_fma_f32 v[80:81], v[190:191], v[108:109], v[80:81] op_sel:[0,0,0] op_sel_hi:[1,0,1]
    v_pk_fma_f32 v[82:83], v[192:193], v[108:109], v[82:83] op_sel:[0,0,0] op_sel_hi:[1,0,1]
    v_pk_fma_f32 v[84:85], v[194:195], v[108:109], v[84:85] op_sel:[0,0,0] op_sel_hi:[1,0,1]
    v_pk_fma_f32 v[86:87], v[196:197], v[108:109], v[86:87] op_sel:[0,0,0] op_sel_hi:[1,0,1]
    v_pk_fma_f32 v[88:89], v[198:199], v[108:109], v[88:89] op_sel:[0,0,0] op_sel_hi:[1,0,1]
    v_pk_fma_f32 v[90:91], v[200:201], v[108:109], v[90:91] op_sel:[0,0,0] op_sel_hi:[1,0,1]
    v_pk_fma_f32 v[92:93], v[202:203], v[108:109], v[92:93] op_sel:[0,0,0] op_sel_hi:[1,0,1]
    v_pk_fma_f32 v[94:95], v[204:205], v[108:109], v[94:95] op_sel:[0,0,0] op_sel_hi:[1,0,1]
    v_pk_fma_f32 v[96:97], v[206:207], v[108:109], v[96:97] op_sel:[0,0,0] op_sel_hi:[1,0,1]
    v_pk_fma_f32 v[98:99], v[208:209], v[108:109], v[98:99] op_sel:[0,0,0] op_sel_hi:[1,0,1]
    v_pk_mul_f32 v[80:81], v[80:81], v[210:211]
    v_pk_mul_f32 v[82:83], v[82:83], v[212:213]
    v_pk_mul_f32 v[84:85], v[84:85], v[214:215]
    v_pk_mul_f32 v[86:87], v[86:87], v[216:217]
    v_pk_mul_f32 v[88:89], v[88:89], v[218:219]
    v_pk_mul_f32 v[90:91], v[90:91], v[220:221]
    v_pk_mul_f32 v[92:93], v[92:93], v[222:223]
    v_pk_mul_f32 v[94:95], v[94:95], v[224:225]
    v_pk_mul_f32 v[96:97], v[96:97], v[226:227]
    v_pk_mul_f32 v[98:99], v[98:99], v[228:229]
    v_cvt_pk_bf16_f32 v110, v80, v81
    v_cvt_pk_bf16_f32 v111, v82, v83
    v_cvt_pk_bf16_f32 v112, v84, v85
    v_cvt_pk_bf16_f32 v113, v86, v87
    v_cvt_pk_bf16_f32 v114, v88, v89
    v_cvt_pk_bf16_f32 v115, v90, v91
    v_cvt_pk_bf16_f32 v116, v92, v93
    v_cvt_pk_bf16_f32 v117, v94, v95
    v_cvt_pk_bf16_f32 v118, v96, v97
    v_cvt_pk_bf16_f32 v119, v98, v99
    v_cndmask_b32 v120, v44, v64, s[64:65]
    v_cndmask_b32 v121, v45, v65, s[66:67]
    v_cndmask_b32 v122, v46, v66, s[68:69]
    v_cndmask_b32 v123, v47, v67, s[70:71]
    v_cndmask_b32 v124, v48, v68, s[64:65]
    v_cndmask_b32 v125, v49, v69, s[66:67]
    v_cndmask_b32 v126, v50, v70, s[68:69]
    v_cndmask_b32 v127, v51, v71, s[70:71]
    v_cndmask_b32 v128, v52, v72, s[64:65]
    v_cndmask_b32 v129, v53, v73, s[66:67]
    v_cndmask_b32 v130, v54, v74, s[68:69]
    v_cndmask_b32 v131, v55, v75, s[70:71]
    v_cndmask_b32 v132, v56, v76, s[64:65]
    v_cndmask_b32 v133, v57, v77, s[66:67]
    v_cndmask_b32 v134, v58, v78, s[68:69]
    v_cndmask_b32 v135, v59, v79, s[70:71]
    v_pk_fma_f32 v[120:121], v[120:121], v[182:183], v[234:235] op_sel:[0,0,0] op_sel_hi:[1,0,1]
    v_pk_fma_f32 v[122:123], v[122:123], v[182:183], v[236:237] op_sel:[0,0,0] op_sel_hi:[1,0,1]
    v_pk_fma_f32 v[124:125], v[124:125], v[184:185], v[230:231] op_sel:[0,0,0] op_sel_hi:[1,0,1]
    v_pk_fma_f32 v[126:127], v[126:127], v[184:185], v[232:233] op_sel:[0,0,0] op_sel_hi:[1,0,1]
    v_pk_fma_f32 v[128:129], v[128:129], v[186:187], v[230:231] op_sel:[0,0,0] op_sel_hi:[1,0,1]
    v_pk_fma_f32 v[130:131], v[130:131], v[186:187], v[232:233] op_sel:[0,0,0] op_sel_hi:[1,0,1]
    v_pk_fma_f32 v[132:133], v[132:133], v[188:189], v[230:231] op_sel:[0,0,0] op_sel_hi:[1,0,1]
    v_pk_fma_f32 v[134:135], v[134:135], v[188:189], v[232:233] op_sel:[0,0,0] op_sel_hi:[1,0,1]
    v_max3_f32 v140, v120, v121, v122
    v_max3_f32 v142, v124, v125, v126
    v_max3_f32 v144, v128, v129, v130
    v_max3_f32 v146, v132, v133, v134
    v_max_f32 v140, v140, v123
    v_max_f32 v142, v142, v127
    v_max_f32 v144, v144, v131
    v_max_f32 v146, v146, v135
    v_mov_b32 v148, v140
    v_mov_b32 v149, v142
    v_mov_b32 v150, v144
    v_mov_b32 v151, v146
    v_permlane16_swap_b32 v140, v148
    v_permlane16_swap_b32 v142, v149
    v_permlane16_swap_b32 v144, v150
    v_permlane16_swap_b32 v146, v151
    v_max_f32 v140, v140, v148
    v_max_f32 v142, v142, v149
    v_max_f32 v144, v144, v150
    v_max_f32 v146, v146, v151
    v_mov_b32 v148, v140
    v_mov_b32 v149, v142
    v_mov_b32 v150, v144
    v_mov_b32 v151, v146
    v_permlane32_swap_b32 v140, v148
    v_permlane32_swap_b32 v142, v149
    v_permlane32_swap_b32 v144, v150
    v_permlane32_swap_b32 v146, v151
    v_max_f32 v140, v140, v148
    v_max_f32 v142, v142, v149
    v_max_f32 v144, v144, v150
    v_max_f32 v146, v146, v151
    v_pk_add_f32 v[120:121], v[120:121], v[140:141] op_sel_hi:[1,0] neg_lo:[0,1] neg_hi:[0,1]
    v_pk_add_f32 v[122:123], v[122:123], v[140:141] op_sel_hi:[1,0] neg_lo:[0,1] neg_hi:[0,1]
    v_pk_add_f32 v[124:125], v[124:125], v[142:143] op_sel_hi:[1,0] neg_lo:[0,1] neg_hi:[0,1]
    v_pk_add_f32 v[126:127], v[126:127], v[142:143] op_sel_hi:[1,0] neg_lo:[0,1] neg_hi:[0,1]
    v_pk_add_f32 v[128:129], v[128:129], v[144:145] op_sel_hi:[1,0] neg_lo:[0,1] neg_hi:[0,1]
    v_pk_add_f32 v[130:131], v[130:131], v[144:145] op_sel_hi:[1,0] neg_lo:[0,1] neg_hi:[0,1]
    v_pk_add_f32 v[132:133], v[132:133], v[146:147] op_sel_hi:[1,0] neg_lo:[0,1] neg_hi:[0,1]
    v_pk_add_f32 v[134:135], v[134:135], v[146:147] op_sel_hi:[1,0] neg_lo:[0,1] neg_hi:[0,1]
    v_exp_f32 v120, v120
    v_exp_f32 v121, v121
    v_exp_f32 v122, v122
    v_exp_f32 v123, v123
    v_exp_f32 v124, v124
    v_exp_f32 v125, v125
    v_exp_f32 v126, v126
    v_exp_f32 v127, v127
    v_exp_f32 v128, v128
    v_exp_f32 v129, v129
    v_exp_f32 v130, v130
    v_exp_f32 v131, v131
    v_exp_f32 v132, v132
    v_exp_f32 v133, v133
    v_exp_f32 v134, v134
    v_exp_f32 v135, v135
    v_add_f32 v152, v120, v121
    v_add_f32 v148, v122, v123
    v_add_f32 v153, v124, v125
    v_add_f32 v149, v126, v127
    v_add_f32 v154, v128, v129
    v_add_f32 v150, v130, v131
    v_add_f32 v155, v132, v133
    v_add_f32 v151, v134, v135
    v_cvt_pk_bf16_f32 v156, v120, v121
    v_cvt_pk_bf16_f32 v157, v122, v123
    v_add_f32 v152, v152, v148
    v_cvt_pk_bf16_f32 v158, v124, v125
    v_cvt_pk_bf16_f32 v159, v126, v127
    v_add_f32 v153, v153, v149
    v_cvt_pk_bf16_f32 v160, v128, v129
    v_cvt_pk_bf16_f32 v161, v130, v131
    v_add_f32 v154, v154, v150
    v_cvt_pk_bf16_f32 v162, v132, v133
    v_cvt_pk_bf16_f32 v163, v134, v135
    v_add_f32 v155, v155, v151
    v_cndmask_b32 v44, v156, 0, s[72:73]
    v_cndmask_b32 v45, v157, 0, s[74:75]
    v_cndmask_b32 v46, 0, v156, s[72:73]
    v_cndmask_b32 v47, 0, v157, s[74:75]
    v_cndmask_b32 v48, v158, 0, s[72:73]
    v_cndmask_b32 v49, v159, 0, s[74:75]
    v_cndmask_b32 v50, 0, v158, s[72:73]
    v_cndmask_b32 v51, 0, v159, s[74:75]
    v_cndmask_b32 v52, v160, 0, s[72:73]
    v_cndmask_b32 v53, v161, 0, s[74:75]
    v_cndmask_b32 v54, 0, v160, s[72:73]
    v_cndmask_b32 v55, 0, v161, s[74:75]
    v_cndmask_b32 v56, v162, 0, s[72:73]
    v_cndmask_b32 v57, v163, 0, s[74:75]
    v_cndmask_b32 v58, 0, v162, s[72:73]
    v_cndmask_b32 v59, 0, v163, s[74:75]
    v_mfma_f32_16x16x32_bf16 v[64:67], v[110:113], v[44:47], 0
    v_mfma_f32_16x16x32_bf16 v[68:71], v[112:115], v[48:51], 0
    v_mfma_f32_16x16x32_bf16 v[72:75], v[114:117], v[52:55], 0
    v_mfma_f32_16x16x32_bf16 v[76:79], v[116:119], v[56:59], 0
    v_mov_b32 v148, v152
    v_mov_b32 v149, v153
    v_mov_b32 v150, v154
    v_mov_b32 v151, v155
    v_permlane16_swap_b32 v152, v148
    v_permlane16_swap_b32 v153, v149
    v_permlane16_swap_b32 v154, v150
    v_permlane16_swap_b32 v155, v151
    v_add_f32 v152, v152, v148
    v_add_f32 v153, v153, v149
    v_add_f32 v154, v154, v150
    v_add_f32 v155, v155, v151
    v_mov_b32 v148, v152
    v_mov_b32 v149, v153
    v_mov_b32 v150, v154
    v_mov_b32 v151, v155
    v_permlane32_swap_b32 v152, v148
    v_permlane32_swap_b32 v153, v149
    v_permlane32_swap_b32 v154, v150
    v_permlane32_swap_b32 v155, v151
    v_add_f32 v152, v152, v148
    v_add_f32 v153, v153, v149
    v_add_f32 v154, v154, v150
    v_add_f32 v155, v155, v151
    v_rcp_f32 v140, v152
    v_rcp_f32 v142, v153
    v_rcp_f32 v144, v154
    v_rcp_f32 v146, v155
    s_and_b32 s54, s46, 1
    s_lshl_b32 s54, s54, 3
    v_add_u32 v168, s54, v1
    s_lshl_b32 s54, s44, 16
    s_lshl_b32 s55, s45, 11
    s_add_u32 s54, s54, s55
    s_lshr_b32 s55, s46, 1
    s_lshl_b32 s55, s55, 10
    s_add_u32 s54, s54, s55
    s_add_u32 s54, s54, s49
    s_add_u32 s54, s54, 8388608
    v_pk_mul_f32 v[64:65], v[64:65], v[140:141] op_sel_hi:[1,0]
    v_pk_mul_f32 v[66:67], v[66:67], v[140:141] op_sel_hi:[1,0]
    v_cvt_pk_bf16_f32 v86, v64, v65
    v_cvt_pk_bf16_f32 v87, v66, v67
    v_pk_mul_f32 v[68:69], v[68:69], v[142:143] op_sel_hi:[1,0]
    v_pk_mul_f32 v[70:71], v[70:71], v[142:143] op_sel_hi:[1,0]
    v_cvt_pk_bf16_f32 v88, v68, v69
    v_cvt_pk_bf16_f32 v89, v70, v71
    v_pk_mul_f32 v[72:73], v[72:73], v[144:145] op_sel_hi:[1,0]
    v_pk_mul_f32 v[74:75], v[74:75], v[144:145] op_sel_hi:[1,0]
    v_cvt_pk_bf16_f32 v90, v72, v73
    v_cvt_pk_bf16_f32 v91, v74, v75
    v_pk_mul_f32 v[76:77], v[76:77], v[146:147] op_sel_hi:[1,0]
    v_pk_mul_f32 v[78:79], v[78:79], v[146:147] op_sel_hi:[1,0]
    v_cvt_pk_bf16_f32 v92, v76, v77
    v_cvt_pk_bf16_f32 v93, v78, v79
    s_nop 7
    s_cmp_eq_u32 s99, 0
    s_cbranch_scc1 L_slow_37
    buffer_store_dwordx2 v[86:87], v168, s[8:11], s54 offen
    s_add_u32 s55, s54, 16384
    buffer_store_dwordx2 v[88:89], v168, s[8:11], s55 offen
    s_add_u32 s55, s54, 32768
    buffer_store_dwordx2 v[90:91], v168, s[8:11], s55 offen
    s_add_u32 s55, s54, 49152
    buffer_store_dwordx2 v[92:93], v168, s[8:11], s55 offen
    s_branch L_join_38
L_slow_37:
    buffer_store_dwordx2 v[86:87], v168, s[8:11], s54 offen sc1
    s_add_u32 s55, s54, 16384
    buffer_store_dwordx2 v[88:89], v168, s[8:11], s55 offen sc1
    s_add_u32 s55, s54, 32768
    buffer_store_dwordx2 v[90:91], v168, s[8:11], s55 offen sc1
    s_add_u32 s55, s54, 49152
    buffer_store_dwordx2 v[92:93], v168, s[8:11], s55 offen sc1
L_join_38:
    s_nop 1
    v_mov_b32 v16, v1
    v_add_u32 v17, 0x10000, v1
    v_add_u32 v18, 0x20000, v1
    v_mov_b32 v32, 0
    v_mov_b32 v33, 0
    v_mov_b32 v34, 0
    v_mov_b32 v35, 0
    v_mov_b32 v36, 0
    v_mov_b32 v37, 0
    v_mov_b32 v38, 0
    v_mov_b32 v39, 0
    v_mov_b32 v40, 0
    v_mov_b32 v41, 0
    v_mov_b32 v42, 0
    v_mov_b32 v43, 0
    v_mov_b32 v44, 0
    v_mov_b32 v45, 0
    v_mov_b32 v46, 0
    v_mov_b32 v47, 0
    s_lshl_b32 s58, s63, 14
    s_add_u32 s58, s58, s49
    s_add_u32 s58, s58, 8388608
    v_and_b32 v251, 7, v15
    s_lshl_b32 s54, s44, 3
    v_add_u32 v251, s54, v251
    v_lshlrev_b32 v251, 2, v251
    s_waitcnt vmcnt(0)
    s_barrier
    s_cmp_lg_u32 s46, 0
    s_cbranch_scc1 L_w0skip_39
    s_lshl_b32 s54, s44, 3
    s_add_u32 s54, s54, s45
    s_lshl_b32 s54, s54, 2
    s_add_u32 s54, s54, s52
    s_add_u32 s54, s54, 26215424
    s_mov_b64 s[92:93], exec
    s_mov_b64 exec, 1
    v_mov_b32 v252, 0
    v_mov_b32 v253, s47
    s_cmp_eq_u32 s99, 0
    s_cbranch_scc1 L_fslow_40
    buffer_store_dword v253, v252, s[8:11], s54 offen
    s_branch L_fjoin_41
L_fslow_40:
    buffer_store_dword v253, v252, s[8:11], s54 offen sc1
L_fjoin_41:
    s_mov_b64 exec, s[92:93]
    s_add_u32 s54, s52, 26215424
    s_mov_b32 s83, 0
L_poll_42:
    buffer_load_dword v253, v251, s[8:11], s54 offen sc1
    s_waitcnt vmcnt(0)
    s_waitcnt vmcnt(0)
    v_and_b32 v252, -16, v253
    v_cmp_ne_u32 vcc, s47, v252
    s_nop 3
    s_cmp_eq_u64 vcc, 0
    s_cbranch_scc1 L_pdone_43
    s_add_u32 s83, s83, 1
    s_cmp_lt_u32 s83, 200000
    s_cbranch_scc1 L_poll_42
L_pdone_43:
L_w0skip_39:
    s_nop 3
    s_barrier
    s_add_u32 s54, s58, 0
    buffer_load_dwordx4 v[96:99], v1, s[8:11], s54 offen sc1
    buffer_load_dwordx4 v[100:103], v1, s[8:11], s54 offen offset:1024 sc1
    buffer_load_dwordx4 v[104:107], v1, s[8:11], s54 offen offset:2048 sc1
    buffer_load_dwordx4 v[108:111], v1, s[8:11], s54 offen offset:3072 sc1
    s_add_u32 s54, s58, 4096
    buffer_load_dwordx4 v[112:115], v1, s[8:11], s54 offen sc1
    buffer_load_dwordx4 v[116:119], v1, s[8:11], s54 offen offset:1024 sc1
    buffer_load_dwordx4 v[120:123], v1, s[8:11], s54 offen offset:2048 sc1
    buffer_load_dwordx4 v[124:127], v1, s[8:11], s54 offen offset:3072 sc1
    s_add_u32 s54, s58, 8192
    buffer_load_dwordx4 v[128:131], v1, s[8:11], s54 offen sc1
    buffer_load_dwordx4 v[132:135], v1, s[8:11], s54 offen offset:1024 sc1
    ds_read_b128 v[48:51], v16 offset:49152
    ds_read_b128 v[52:55], v16 offset:50176
    ds_read_b128 v[56:59], v16 offset:51200
    ds_read_b128 v[60:63], v16 offset:52224
    ds_read_b128 v[64:67], v16 offset:53248
    ds_read_b128 v[68:71], v16 offset:54272
    s_waitcnt vmcnt(9)
    s_waitcnt lgkmcnt(4)
    v_mfma_f32_16x16x32_bf16 v[32:35], v[48:51], v[96:99], v[32:35]
    ds_read_b128 v[72:75], v16 offset:55296
    v_mfma_f32_16x16x32_bf16 v[36:39], v[52:55], v[96:99], v[36:39]
    ds_read_b128 v[76:79], v16 offset:56320
    buffer_load_dwordx4 v[136:139], v1, s[8:11], s54 offen offset:2048 sc1
    s_waitcnt lgkmcnt(4)
    v_mfma_f32_16x16x32_bf16 v[40:43], v[56:59], v[96:99], v[40:43]
    ds_read_b128 v[48:51], v16 offset:57344
    v_mfma_f32_16x16x32_bf16 v[44:47], v[60:63], v[96:99], v[44:47]
    ds_read_b128 v[52:55], v16 offset:58368
    buffer_load_dwordx4 v[140:143], v1, s[8:11], s54 offen offset:3072 sc1
    s_waitcnt vmcnt(10)
    s_waitcnt lgkmcnt(4)
    v_mfma_f32_16x16x32_bf16 v[32:35], v[64:67], v[100:103], v[32:35]
    ds_read_b128 v[56:59], v16 offset:59392
    v_mfma_f32_16x16x32_bf16 v[36:39], v[68:71], v[100:103], v[36:39]
    ds_read_b128 v[60:63], v16 offset:60416
    s_add_u32 s54, s58, 12288
    buffer_load_dwordx4 v[144:147], v1, s[8:11], s54 offen sc1
    s_waitcnt lgkmcnt(4)
    v_mfma_f32_16x16x32_bf16 v[40:43], v[72:75], v[100:103], v[40:43]
    ds_read_b128 v[64:67], v16 offset:61440
    v_mfma_f32_16x16x32_bf16 v[44:47], v[76:79], v[100:103], v[44:47]
    ds_read_b128 v[68:71], v16 offset:62464
    s_waitcnt vmcnt(10)
    s_waitcnt lgkmcnt(4)
    v_mfma_f32_16x16x32_bf16 v[32:35], v[48:51], v[104:107], v[32:35]
    ds_read_b128 v[72:75], v16 offset:63488
    v_mfma_f32_16x16x32_bf16 v[36:39], v[52:55], v[104:107], v[36:39]
    ds_read_b128 v[76:79], v16 offset:64512
    buffer_load_dwordx4 v[148:151], v1, s[8:11], s54 offen offset:1024 sc1
    s_waitcnt lgkmcnt(4)
    v_mfma_f32_16x16x32_bf16 v[40:43], v[56:59], v[104:107], v[40:43]
    ds_read_b128 v[48:51], v17 offset:0
    v_mfma_f32_16x16x32_bf16 v[44:47], v[60:63], v[104:107], v[44:47]
    ds_read_b128 v[52:55], v17 offset:1024
    s_waitcnt vmcnt(10)
    s_waitcnt lgkmcnt(4)
    v_mfma_f32_16x16x32_bf16 v[32:35], v[64:67], v[108:111], v[32:35]
    ds_read_b128 v[56:59], v17 offset:2048
    v_mfma_f32_16x16x32_bf16 v[36:39], v[68:71], v[108:111], v[36:39]
    ds_read_b128 v[60:63], v17 offset:3072
    buffer_load_dwordx4 v[152:155], v1, s[8:11], s54 offen offset:2048 sc1
    s_barrier
    s_waitcnt lgkmcnt(4)
    v_mfma_f32_16x16x32_bf16 v[40:43], v[72:75], v[108:111], v[40:43]
    ds_read_b128 v[64:67], v17 offset:4096
    v_mfma_f32_16x16x32_bf16 v[44:47], v[76:79], v[108:111], v[44:47]
    ds_read_b128 v[68:71], v17 offset:5120
    s_waitcnt vmcnt(10)
    s_waitcnt lgkmcnt(4)
    v_mfma_f32_16x16x32_bf16 v[32:35], v[48:51], v[112:115], v[32:35]
    ds_read_b128 v[72:75], v17 offset:6144
    v_mfma_f32_16x16x32_bf16 v[36:39], v[52:55], v[112:115], v[36:39]
    ds_read_b128 v[76:79], v17 offset:7168
    buffer_load_dwordx4 v[156:159], v1, s[8:11], s54 offen offset:3072 sc1
    s_waitcnt lgkmcnt(4)
    v_mfma_f32_16x16x32_bf16 v[40:43], v[56:59], v[112:115], v[40:43]
    ds_read_b128 v[48:51], v16 offset:0
    v_mfma_f32_16x16x32_bf16 v[44:47], v[60:63], v[112:115], v[44:47]
    ds_read_b128 v[52:55], v16 offset:1024
    s_waitcnt vmcnt(10)
    s_waitcnt lgkmcnt(4)
    v_mfma_f32_16x16x32_bf16 v[32:35], v[64:67], v[116:119], v[32:35]
    ds_read_b128 v[56:59], v16 offset:2048
    v_mfma_f32_16x16x32_bf16 v[36:39], v[68:71], v[116:119], v[36:39]
    ds_read_b128 v[60:63], v16 offset:3072
    s_waitcnt lgkmcnt(4)
    v_mfma_f32_16x16x32_bf16 v[40:43], v[72:75], v[116:119], v[40:43]
    ds_read_b128 v[64:67], v16 offset:4096
    v_mfma_f32_16x16x32_bf16 v[44:47], v[76:79], v[116:119], v[44:47]
    ds_read_b128 v[68:71], v16 offset:5120
    s_waitcnt vmcnt(9)
    s_waitcnt lgkmcnt(4)
    v_mfma_f32_16x16x32_bf16 v[32:35], v[48:51], v[120:123], v[32:35]
    ds_read_b128 v[72:75], v16 offset:6144
    v_mfma_f32_16x16x32_bf16 v[36:39], v[52:55], v[120:123], v[36:39]
    ds_read_b128 v[76:79], v16 offset:7168
    s_waitcnt lgkmcnt(4)
    v_mfma_f32_16x16x32_bf16 v[40:43], v[56:59], v[120:123], v[40:43]
    ds_read_b128 v[48:51], v16 offset:8192
    v_mfma_f32_16x16x32_bf16 v[44:47], v[60:63], v[120:123], v[44:47]
    ds_read_b128 v[52:55], v16 offset:9216
    s_waitcnt vmcnt(8)
    s_waitcnt lgkmcnt(4)
    v_mfma_f32_16x16x32_bf16 v[32:35], v[64:67], v[124:127], v[32:35]
    ds_read_b128 v[56:59], v16 offset:10240
    v_mfma_f32_16x16x32_bf16 v[36:39], v[68:71], v[124:127], v[36:39]
    ds_read_b128 v[60:63], v16 offset:11264
    s_waitcnt lgkmcnt(4)
    v_mfma_f32_16x16x32_bf16 v[40:43], v[72:75], v[124:127], v[40:43]
    ds_read_b128 v[64:67], v16 offset:12288
    v_mfma_f32_16x16x32_bf16 v[44:47], v[76:79], v[124:127], v[44:47]
    ds_read_b128 v[68:71], v16 offset:13312
    s_waitcnt vmcnt(7)
    s_waitcnt lgkmcnt(4)
    v_mfma_f32_16x16x32_bf16 v[32:35], v[48:51], v[128:131], v[32:35]
    ds_read_b128 v[72:75], v16 offset:14336
    v_mfma_f32_16x16x32_bf16 v[36:39], v[52:55], v[128:131], v[36:39]
    ds_read_b128 v[76:79], v16 offset:15360
    s_waitcnt lgkmcnt(4)
    v_mfma_f32_16x16x32_bf16 v[40:43], v[56:59], v[128:131], v[40:43]
    ds_read_b128 v[48:51], v16 offset:16384
    v_mfma_f32_16x16x32_bf16 v[44:47], v[60:63], v[128:131], v[44:47]
    ds_read_b128 v[52:55], v16 offset:17408
    s_waitcnt vmcnt(6)
    s_waitcnt lgkmcnt(4)
    v_mfma_f32_16x16x32_bf16 v[32:35], v[64:67], v[132:135], v[32:35]
    ds_read_b128 v[56:59], v16 offset:18432
    v_mfma_f32_16x16x32_bf16 v[36:39], v[68:71], v[132:135], v[36:39]
    ds_read_b128 v[60:63], v16 offset:19456
    s_waitcnt lgkmcnt(4)
    v_mfma_f32_16x16x32_bf16 v[40:43], v[72:75], v[132:135], v[40:43]
    ds_read_b128 v[64:67], v16 offset:20480
    v_mfma_f32_16x16x32_bf16 v[44:47], v[76:79], v[132:135], v[44:47]
    ds_read_b128 v[68:71], v16 offset:21504
    s_waitcnt vmcnt(5)
    s_waitcnt lgkmcnt(4)
    v_mfma_f32_16x16x32_bf16 v[32:35], v[48:51], v[136:139], v[32:35]
    ds_read_b128 v[72:75], v16 offset:22528
    v_mfma_f32_16x16x32_bf16 v[36:39], v[52:55], v[136:139], v[36:39]
    ds_read_b128 v[76:79], v16 offset:23552
    s_waitcnt lgkmcnt(4)
    v_mfma_f32_16x16x32_bf16 v[40:43], v[56:59], v[136:139], v[40:43]
    ds_read_b128 v[48:51], v16 offset:24576
    v_mfma_f32_16x16x32_bf16 v[44:47], v[60:63], v[136:139], v[44:47]
    ds_read_b128 v[52:55], v16 offset:25600
    s_waitcnt vmcnt(4)
    s_waitcnt lgkmcnt(4)
    v_mfma_f32_16x16x32_bf16 v[32:35], v[64:67], v[140:143], v[32:35]
    ds_read_b128 v[56:59], v16 offset:26624
    v_mfma_f32_16x16x32_bf16 v[36:39], v[68:71], v[140:143], v[36:39]
    ds_read_b128 v[60:63], v16 offset:27648
    s_waitcnt lgkmcnt(4)
    v_mfma_f32_16x16x32_bf16 v[40:43], v[72:75], v[140:143], v[40:43]
    ds_read_b128 v[64:67], v16 offset:28672
    v_mfma_f32_16x16x32_bf16 v[44:47], v[76:79], v[140:143], v[44:47]
    ds_read_b128 v[68:71], v16 offset:29696
    s_waitcnt vmcnt(3)
    s_waitcnt lgkmcnt(4)
    v_mfma_f32_16x16x32_bf16 v[32:35], v[48:51], v[144:147], v[32:35]
    ds_read_b128 v[72:75], v16 offset:30720
    v_mfma_f32_16x16x32_bf16 v[36:39], v[52:55], v[144:147], v[36:39]
    ds_read_b128 v[76:79], v16 offset:31744
    s_waitcnt lgkmcnt(4)
    v_mfma_f32_16x16x32_bf16 v[40:43], v[56:59], v[144:147], v[40:43]
    ds_read_b128 v[48:51], v16 offset:32768
    v_mfma_f32_16x16x32_bf16 v[44:47], v[60:63], v[144:147], v[44:47]
    ds_read_b128 v[52:55], v16 offset:33792
    s_waitcnt vmcnt(2)
    s_waitcnt lgkmcnt(4)
    v_mfma_f32_16x16x32_bf16 v[32:35], v[64:67], v[148:151], v[32:35]
    ds_read_b128 v[56:59], v16 offset:34816
    v_mfma_f32_16x16x32_bf16 v[36:39], v[68:71], v[148:151], v[36:39]
    ds_read_b128 v[60:63], v16 offset:35840
    s_waitcnt lgkmcnt(4)
    v_mfma_f32_16x16x32_bf16 v[40:43], v[72:75], v[148:151], v[40:43]
    ds_read_b128 v[64:67], v16 offset:36864
    v_mfma_f32_16x16x32_bf16 v[44:47], v[76:79], v[148:151], v[44:47]
    ds_read_b128 v[68:71], v16 offset:37888
    s_waitcnt vmcnt(1)
    s_waitcnt lgkmcnt(4)
    v_mfma_f32_16x16x32_bf16 v[32:35], v[48:51], v[152:155], v[32:35]
    ds_read_b128 v[72:75], v16 offset:38912
    v_mfma_f32_16x16x32_bf16 v[36:39], v[52:55], v[152:155], v[36:39]
    ds_read_b128 v[76:79], v16 offset:39936
    s_waitcnt lgkmcnt(4)
    v_mfma_f32_16x16x32_bf16 v[40:43], v[56:59], v[152:155], v[40:43]
    v_mfma_f32_16x16x32_bf16 v[44:47], v[60:63], v[152:155], v[44:47]
    s_waitcnt vmcnt(0)
    s_waitcnt lgkmcnt(2)
    v_mfma_f32_16x16x32_bf16 v[32:35], v[64:67], v[156:159], v[32:35]
    v_mfma_f32_16x16x32_bf16 v[36:39], v[68:71], v[156:159], v[36:39]
    s_waitcnt lgkmcnt(0)
    v_mfma_f32_16x16x32_bf16 v[40:43], v[72:75], v[156:159], v[40:43]
    v_mfma_f32_16x16x32_bf16 v[44:47], v[76:79], v[156:159], v[44:47]
    s_waitcnt lgkmcnt(0)
    s_barrier
    v_lshlrev_b32 v80, 16, v2
    v_and_b32 v81, 0xffff0000, v2
    v_pk_add_f32 v[80:81], v[80:81], v[32:33]
    v_cvt_pk_bf16_f32 v2, v80, v81
    v_lshlrev_b32 v82, 16, v3
    v_and_b32 v83, 0xffff0000, v3
    v_pk_add_f32 v[82:83], v[82:83], v[34:35]
    v_cvt_pk_bf16_f32 v3, v82, v83
    v_lshlrev_b32 v84, 16, v4
    v_and_b32 v85, 0xffff0000, v4
    v_pk_add_f32 v[84:85], v[84:85], v[36:37]
    v_cvt_pk_bf16_f32 v4, v84, v85
    v_lshlrev_b32 v86, 16, v5
    v_and_b32 v87, 0xffff0000, v5
    v_pk_add_f32 v[86:87], v[86:87], v[38:39]
    v_cvt_pk_bf16_f32 v5, v86, v87
    v_lshlrev_b32 v80, 16, v6
    v_and_b32 v81, 0xffff0000, v6
    v_pk_add_f32 v[80:81], v[80:81], v[40:41]
    v_cvt_pk_bf16_f32 v6, v80, v81
    v_lshlrev_b32 v82, 16, v7
    v_and_b32 v83, 0xffff0000, v7
    v_pk_add_f32 v[82:83], v[82:83], v[42:43]
    v_cvt_pk_bf16_f32 v7, v82, v83
    v_lshlrev_b32 v84, 16, v8
    v_and_b32 v85, 0xffff0000, v8
    v_pk_add_f32 v[84:85], v[84:85], v[44:45]
    v_cvt_pk_bf16_f32 v8, v84, v85
    v_lshlrev_b32 v86, 16, v9
    v_and_b32 v87, 0xffff0000, v9
    v_pk_add_f32 v[86:87], v[86:87], v[46:47]
    v_cvt_pk_bf16_f32 v9, v86, v87
    s_add_u32 s56, s49, 4194304
    s_add_u32 s57, s51, 25427968
    v_lshrrev_b32 v239, 4, v15
    v_lshlrev_b32 v239, 9, v239
    v_and_b32 v241, 15, v15
    v_lshl_add_u32 v239, v241, 4, v239
    s_lshr_b32 s54, s63, 1
    s_lshl_b32 s54, s54, 15
    s_lshl_b32 s55, s45, 12
    s_add_u32 s54, s54, s55
    s_and_b32 s55, s63, 1
    s_lshl_b32 s55, s55, 8
    s_add_u32 s54, s54, s55
    s_add_u32 s54, s54, s56
    s_nop 7
    s_cmp_eq_u32 s99, 0
    s_cbranch_scc1 L_slow_44
    buffer_store_dwordx4 v[2:5], v239, s[8:11], s54 offen
    buffer_store_dwordx4 v[6:9], v239, s[8:11], s54 offen offset:2048
    s_branch L_join_45
L_slow_44:
    buffer_store_dwordx4 v[2:5], v239, s[8:11], s54 offen sc1
    buffer_store_dwordx4 v[6:9], v239, s[8:11], s54 offen offset:2048 sc1
L_join_45:
    s_nop 1
    v_mov_b32 v244, 0
    v_mov_b32 v245, 0
    v_mov_b32 v246, 0
    v_mov_b32 v247, 0
    v_dot2c_f32_bf16 v244, s62, v2
    v_dot2c_f32_bf16 v246, v2, v2
    v_dot2c_f32_bf16 v245, s62, v3
    v_dot2c_f32_bf16 v247, v3, v3
    v_dot2c_f32_bf16 v244, s62, v4
    v_dot2c_f32_bf16 v246, v4, v4
    v_dot2c_f32_bf16 v245, s62, v5
    v_dot2c_f32_bf16 v247, v5, v5
    v_dot2c_f32_bf16 v244, s62, v6
    v_dot2c_f32_bf16 v246, v6, v6
    v_dot2c_f32_bf16 v245, s62, v7
    v_dot2c_f32_bf16 v247, v7, v7
    v_dot2c_f32_bf16 v244, s62, v8
    v_dot2c_f32_bf16 v246, v8, v8
    v_dot2c_f32_bf16 v245, s62, v9
    v_dot2c_f32_bf16 v247, v9, v9
    v_lshlrev_b32 v240, 6, v15
    s_lshl_b32 s54, s63, 10
    s_lshl_b32 s55, s45, 3
    v_add_f32 v244, v244, v245
    v_add_f32 v245, v246, v247
    s_add_u32 s54, s54, s55
    s_add_u32 s54, s54, s57
    v_mov_b32 v242, v244
    v_mov_b32 v243, v245
    s_nop 0
    v_permlane16_swap_b32 v244, v242
    v_permlane16_swap_b32 v245, v243
    v_add_f32 v244, v244, v242
    v_add_f32 v245, v245, v243
    v_mov_b32 v242, v244
    v_mov_b32 v243, v245
    s_nop 0
    v_permlane32_swap_b32 v244, v242
    v_permlane32_swap_b32 v245, v243
    v_add_f32 v244, v244, v242
    v_add_f32 v245, v245, v243
    s_mov_b64 exec, s[78:79]
    s_nop 7
    s_cmp_eq_u32 s99, 0
    s_cbranch_scc1 L_slow_46
    buffer_store_dwordx2 v[244:245], v240, s[8:11], s54 offen
    s_branch L_join_47
L_slow_46:
    buffer_store_dwordx2 v[244:245], v240, s[8:11], s54 offen sc1
L_join_47:
    s_nop 1
    s_mov_b64 exec, -1
    v_mov_b32 v16, v1
    v_add_u32 v17, 0x10000, v1
    v_add_u32 v18, 0x20000, v1
    v_mov_b32 v152, 0
    v_mov_b32 v153, 0
    v_mov_b32 v154, 0
    v_mov_b32 v155, 0
    v_mov_b32 v156, 0
    v_mov_b32 v157, 0
    v_mov_b32 v158, 0
    v_mov_b32 v159, 0
    v_mov_b32 v160, 0
    v_mov_b32 v161, 0
    v_mov_b32 v162, 0
    v_mov_b32 v163, 0
    v_mov_b32 v164, 0
    v_mov_b32 v165, 0
    v_mov_b32 v166, 0
    v_mov_b32 v167, 0
    v_mov_b32 v168, 0
    v_mov_b32 v169, 0
    v_mov_b32 v170, 0
    v_mov_b32 v171, 0
    v_mov_b32 v172, 0
    v_mov_b32 v173, 0
    v_mov_b32 v174, 0
    v_mov_b32 v175, 0
    v_mov_b32 v176, 0
    v_mov_b32 v177, 0
    v_mov_b32 v178, 0
    v_mov_b32 v179, 0
    v_mov_b32 v180, 0
    v_mov_b32 v181, 0
    v_mov_b32 v182, 0
    v_mov_b32 v183, 0
    v_mov_b32 v184, 0
    v_mov_b32 v185, 0
    v_mov_b32 v186, 0
    v_mov_b32 v187, 0
    v_mov_b32 v188, 0
    v_mov_b32 v189, 0
    v_mov_b32 v190, 0
    v_mov_b32 v191, 0
    v_mov_b32 v192, 0
    v_mov_b32 v193, 0
    v_mov_b32 v194, 0
    v_mov_b32 v195, 0
    v_mov_b32 v196, 0
    v_mov_b32 v197, 0
    v_mov_b32 v198, 0
    v_mov_b32 v199, 0
    v_mov_b32 v200, 0
    v_mov_b32 v201, 0
    v_mov_b32 v202, 0
    v_mov_b32 v203, 0
    v_mov_b32 v204, 0
    v_mov_b32 v205, 0
    v_mov_b32 v206, 0
    v_mov_b32 v207, 0
    v_mov_b32 v208, 0
    v_mov_b32 v209, 0
    v_mov_b32 v210, 0
    v_mov_b32 v211, 0
    v_mov_b32 v212, 0
    v_mov_b32 v213, 0
    v_mov_b32 v214, 0
    v_mov_b32 v215, 0
    v_mov_b32 v216, 0
    v_mov_b32 v217, 0
    v_mov_b32 v218, 0
    v_mov_b32 v219, 0
    v_mov_b32 v220, 0
    v_mov_b32 v221, 0
    v_mov_b32 v222, 0
    v_mov_b32 v223, 0
    v_mov_b32 v224, 0
    v_mov_b32 v225, 0
    v_mov_b32 v226, 0
    v_mov_b32 v227, 0
    v_mov_b32 v228, 0
    v_mov_b32 v229, 0
    v_mov_b32 v230, 0
    v_mov_b32 v231, 0
    v_mov_b32 v232, 0
    v_mov_b32 v233, 0
    v_mov_b32 v234, 0
    v_mov_b32 v235, 0
    v_mov_b32 v236, 0
    v_mov_b32 v237, 0
    v_mov_b32 v238, 0
    v_mov_b32 v239, 0
    v_mov_b32 v240, 0
    v_mov_b32 v241, 0
    v_mov_b32 v242, 0
    v_mov_b32 v243, 0
    v_mov_b32 v244, 0
    v_mov_b32 v245, 0
    v_mov_b32 v246, 0
    v_mov_b32 v247, 0
    v_and_b32 v28, 31, v15
    v_lshlrev_b32 v28, 6, v28
    v_lshrrev_b32 v29, 5, v15
    v_lshl_add_u32 v28, v29, 5, v28
    s_lshl_b32 s58, s82, 11
    s_add_u32 s58, s58, s51
    s_add_u32 s58, s58, 25427968
    s_lshl_b32 s57, s82, 15
    s_add_u32 s57, s57, s49
    s_add_u32 s57, s57, 4194304
    v_and_b32 v251, 15, v15
    s_lshr_b32 s54, s44, 1
    s_lshl_b32 s54, s54, 4
    v_add_u32 v251, s54, v251
    v_lshlrev_b32 v251, 2, v251
    s_waitcnt vmcnt(0)
    s_barrier
    s_cmp_lg_u32 s46, 0
    s_cbranch_scc1 L_w0skip_48
    s_lshl_b32 s54, s44, 3
    s_add_u32 s54, s54, s45
    s_lshl_b32 s54, s54, 2
    s_add_u32 s54, s54, s52
    s_add_u32 s54, s54, 26216448
    s_mov_b64 s[92:93], exec
    s_mov_b64 exec, 1
    v_mov_b32 v252, 0
    v_mov_b32 v253, s47
    s_cmp_eq_u32 s99, 0
    s_cbranch_scc1 L_fslow_49
    buffer_store_dword v253, v252, s[8:11], s54 offen
    s_branch L_fjoin_50
L_fslow_49:
    buffer_store_dword v253, v252, s[8:11], s54 offen sc1
L_fjoin_50:
    s_mov_b64 exec, s[92:93]
    s_add_u32 s54, s52, 26216448
    s_mov_b32 s83, 0
L_poll_51:
    buffer_load_dword v253, v251, s[8:11], s54 offen sc1
    s_waitcnt vmcnt(0)
    s_waitcnt vmcnt(0)
    v_and_b32 v252, -16, v253
    v_cmp_ne_u32 vcc, s47, v252
    s_nop 3
    s_cmp_eq_u64 vcc, 0
    s_cbranch_scc1 L_pdone_52
    s_add_u32 s83, s83, 1
    s_cmp_lt_u32 s83, 200000
    s_cbranch_scc1 L_poll_51
L_pdone_52:
L_w0skip_48:
    s_nop 3
    s_barrier
    s_add_u32 s56, s57, 0
    buffer_load_dwordx4 v[80:83], v1, s[8:11], s56 offen sc1
    buffer_load_dwordx4 v[84:87], v1, s[8:11], s56 offen offset:1024 sc1
    buffer_load_dwordx4 v[88:91], v1, s[8:11], s56 offen offset:2048 sc1
    buffer_load_dwordx4 v[92:95], v1, s[8:11], s56 offen offset:3072 sc1
    s_add_u32 s56, s57, 4096
    buffer_load_dwordx4 v[96:99], v1, s[8:11], s56 offen sc1
    buffer_load_dwordx4 v[100:103], v1, s[8:11], s56 offen offset:1024 sc1
    buffer_load_dwordx4 v[104:107], v1, s[8:11], s56 offen offset:2048 sc1
    buffer_load_dwordx4 v[108:111], v1, s[8:11], s56 offen offset:3072 sc1
    buffer_load_dwordx4 v[20:23], v28, s[8:11], s58 offen sc1
    buffer_load_dwordx4 v[24:27], v28, s[8:11], s58 offen offset:16 sc1
    ds_read_b128 v[32:35], v17 offset:8192
    ds_read_b128 v[36:39], v17 offset:9216
    ds_read_b128 v[40:43], v17 offset:12288
    ds_read_b128 v[44:47], v17 offset:13312
    ds_read_b128 v[48:51], v17 offset:16384
    ds_read_b128 v[52:55], v17 offset:17408
    ds_read_b128 v[56:59], v17 offset:10240
    ds_read_b128 v[60:63], v17 offset:11264
    s_waitcnt vmcnt(9)
    s_waitcnt lgkmcnt(6)
    v_mfma_f32_32x32x16_bf16 v[152:167], v[32:35], v[80:83], v[152:167]
    ds_read_b128 v[64:67], v17 offset:14336
    v_mfma_f32_32x32x16_bf16 v[168:183], v[36:39], v[80:83], v[168:183]
    ds_read_b128 v[68:71], v17 offset:15360
    s_waitcnt lgkmcnt(6)
    v_mfma_f32_32x32x16_bf16 v[184:199], v[40:43], v[80:83], v[184:199]
    ds_read_b128 v[72:75], v17 offset:18432
    s_add_u32 s56, s57, 8192
    buffer_load_dwordx4 v[112:115], v1, s[8:11], s56 offen sc1
    v_mfma_f32_32x32x16_bf16 v[200:215], v[44:47], v[80:83], v[200:215]
    ds_read_b128 v[76:79], v17 offset:19456
    s_waitcnt lgkmcnt(6)
    v_mfma_f32_32x32x16_bf16 v[216:231], v[48:51], v[80:83], v[216:231]
    ds_read_b128 v[32:35], v17 offset:20480
    buffer_load_dwordx4 v[116:119], v1, s[8:11], s56 offen offset:1024 sc1
    v_mfma_f32_32x32x16_bf16 v[232:247], v[52:55], v[80:83], v[232:247]
    ds_read_b128 v[36:39], v17 offset:21504
    s_waitcnt vmcnt(10)
    s_waitcnt lgkmcnt(6)
    v_mfma_f32_32x32x16_bf16 v[152:167], v[56:59], v[84:87], v[152:167]
    ds_read_b128 v[40:43], v17 offset:24576
    v_mfma_f32_32x32x16_bf16 v[168:183], v[60:63], v[84:87], v[168:183]
    ds_read_b128 v[44:47], v17 offset:25600
    s_waitcnt lgkmcnt(6)
    v_mfma_f32_32x32x16_bf16 v[184:199], v[64:67], v[84:87], v[184:199]
    ds_read_b128 v[48:51], v17 offset:28672
    buffer_load_dwordx4 v[120:123], v1, s[8:11], s56 offen offset:2048 sc1
    v_mfma_f32_32x32x16_bf16 v[200:215], v[68:71], v[84:87], v[200:215]
    ds_read_b128 v[52:55], v17 offset:29696
    s_waitcnt lgkmcnt(6)
    v_mfma_f32_32x32x16_bf16 v[216:231], v[72:75], v[84:87], v[216:231]
    ds_read_b128 v[56:59], v17 offset:22528
    buffer_load_dwordx4 v[124:127], v1, s[8:11], s56 offen offset:3072 sc1
    v_mfma_f32_32x32x16_bf16 v[232:247], v[76:79], v[84:87], v[232:247]
    ds_read_b128 v[60:63], v17 offset:23552
    s_waitcnt vmcnt(11)
    s_waitcnt lgkmcnt(6)
    v_mfma_f32_32x32x16_bf16 v[152:167], v[32:35], v[88:91], v[152:167]
    ds_read_b128 v[64:67], v17 offset:26624
    v_mfma_f32_32x32x16_bf16 v[168:183], v[36:39], v[88:91], v[168:183]
    ds_read_b128 v[68:71], v17 offset:27648
    s_waitcnt lgkmcnt(6)
    v_mfma_f32_32x32x16_bf16 v[184:199], v[40:43], v[88:91], v[184:199]
    ds_read_b128 v[72:75], v17 offset:30720
    s_add_u32 s56, s57, 12288
    buffer_load_dwordx4 v[128:131], v1, s[8:11], s56 offen sc1
    v_mfma_f32_32x32x16_bf16 v[200:215], v[44:47], v[88:91], v[200:215]
    ds_read_b128 v[76:79], v17 offset:31744
    s_barrier
    s_waitcnt lgkmcnt(6)
    v_mfma_f32_32x32x16_bf16 v[216:231], v[48:51], v[88:91], v[216:231]
    ds_read_b128 v[32:35], v17 offset:32768
    buffer_load_dwordx4 v[132:135], v1, s[8:11], s56 offen offset:1024 sc1
    v_mfma_f32_32x32x16_bf16 v[232:247], v[52:55], v[88:91], v[232:247]
    ds_read_b128 v[36:39], v17 offset:33792
    s_waitcnt vmcnt(12)
    s_waitcnt lgkmcnt(6)
    v_mfma_f32_32x32x16_bf16 v[152:167], v[56:59], v[92:95], v[152:167]
    ds_read_b128 v[40:43], v17 offset:36864
    v_mfma_f32_32x32x16_bf16 v[168:183], v[60:63], v[92:95], v[168:183]
    ds_read_b128 v[44:47], v17 offset:37888
    s_waitcnt lgkmcnt(6)
    v_mfma_f32_32x32x16_bf16 v[184:199], v[64:67], v[92:95], v[184:199]
    ds_read_b128 v[48:51], v17 offset:40960
    buffer_load_dwordx4 v[136:139], v1, s[8:11], s56 offen offset:2048 sc1
    v_mfma_f32_32x32x16_bf16 v[200:215], v[68:71], v[92:95], v[200:215]
    ds_read_b128 v[52:55], v17 offset:41984
    s_waitcnt lgkmcnt(6)
    v_mfma_f32_32x32x16_bf16 v[216:231], v[72:75], v[92:95], v[216:231]
    ds_read_b128 v[56:59], v17 offset:34816
    v_mfma_f32_32x32x16_bf16 v[232:247], v[76:79], v[92:95], v[232:247]
    ds_read_b128 v[60:63], v17 offset:35840
    s_waitcnt vmcnt(12)
    s_waitcnt lgkmcnt(6)
    v_mfma_f32_32x32x16_bf16 v[152:167], v[32:35], v[96:99], v[152:167]
    ds_read_b128 v[64:67], v17 offset:38912
    v_mfma_f32_32x32x16_bf16 v[168:183], v[36:39], v[96:99], v[168:183]
    ds_read_b128 v[68:71], v17 offset:39936
    s_waitcnt lgkmcnt(6)
    v_mfma_f32_32x32x16_bf16 v[184:199], v[40:43], v[96:99], v[184:199]
    ds_read_b128 v[72:75], v17 offset:43008
    buffer_load_dwordx4 v[140:143], v1, s[8:11], s56 offen offset:3072 sc1
    v_mfma_f32_32x32x16_bf16 v[200:215], v[44:47], v[96:99], v[200:215]
    ds_read_b128 v[76:79], v17 offset:44032
    s_waitcnt lgkmcnt(6)
    v_mfma_f32_32x32x16_bf16 v[216:231], v[48:51], v[96:99], v[216:231]
    ds_read_b128 v[32:35], v17 offset:45056
    v_mfma_f32_32x32x16_bf16 v[232:247], v[52:55], v[96:99], v[232:247]
    ds_read_b128 v[36:39], v17 offset:46080
    s_waitcnt vmcnt(12)
    s_waitcnt lgkmcnt(6)
    v_mfma_f32_32x32x16_bf16 v[152:167], v[56:59], v[100:103], v[152:167]
    ds_read_b128 v[40:43], v17 offset:49152
    v_mfma_f32_32x32x16_bf16 v[168:183], v[60:63], v[100:103], v[168:183]
    ds_read_b128 v[44:47], v17 offset:50176
    s_waitcnt lgkmcnt(6)
    v_mfma_f32_32x32x16_bf16 v[184:199], v[64:67], v[100:103], v[184:199]
    ds_read_b128 v[48:51], v17 offset:53248
    s_add_u32 s56, s57, 16384
    buffer_load_dwordx4 v[144:147], v1, s[8:11], s56 offen sc1
    v_mfma_f32_32x32x16_bf16 v[200:215], v[68:71], v[100:103], v[200:215]
    ds_read_b128 v[52:55], v17 offset:54272
    s_waitcnt lgkmcnt(6)
    v_mfma_f32_32x32x16_bf16 v[216:231], v[72:75], v[100:103], v[216:231]
    ds_read_b128 v[56:59], v17 offset:47104
    v_mfma_f32_32x32x16_bf16 v[232:247], v[76:79], v[100:103], v[232:247]
    ds_read_b128 v[60:63], v17 offset:48128
    s_waitcnt vmcnt(12)
    s_waitcnt lgkmcnt(6)
    v_mfma_f32_32x32x16_bf16 v[152:167], v[32:35], v[104:107], v[152:167]
    ds_read_b128 v[64:67], v17 offset:51200
    s_waitcnt vmcnt(10)
    v_add_f32 v20, v20, v22
    v_mfma_f32_32x32x16_bf16 v[168:183], v[36:39], v[104:107], v[168:183]
    ds_read_b128 v[68:71], v17 offset:52224
    v_add_f32 v21, v21, v23
    s_waitcnt lgkmcnt(6)
    v_mfma_f32_32x32x16_bf16 v[184:199], v[40:43], v[104:107], v[184:199]
    ds_read_b128 v[72:75], v17 offset:55296
    buffer_load_dwordx4 v[148:151], v1, s[8:11], s56 offen offset:1024 sc1
    s_waitcnt vmcnt(10)
    v_add_f32 v20, v20, v24
    v_mfma_f32_32x32x16_bf16 v[200:215], v[44:47], v[104:107], v[200:215]
    ds_read_b128 v[76:79], v17 offset:56320
    v_add_f32 v21, v21, v25
    s_barrier
    s_waitcnt lgkmcnt(6)
    v_mfma_f32_32x32x16_bf16 v[216:231], v[48:51], v[104:107], v[216:231]
    ds_read_b128 v[32:35], v17 offset:57344
    v_add_f32 v20, v20, v26
    v_mfma_f32_32x32x16_bf16 v[232:247], v[52:55], v[104:107], v[232:247]
    ds_read_b128 v[36:39], v17 offset:58368
    v_add_f32 v21, v21, v27
    s_waitcnt lgkmcnt(6)
    v_mfma_f32_32x32x16_bf16 v[152:167], v[56:59], v[108:111], v[152:167]
    ds_read_b128 v[40:43], v17 offset:61440
    v_mov_b32 v28, v20
    v_mfma_f32_32x32x16_bf16 v[168:183], v[60:63], v[108:111], v[168:183]
    ds_read_b128 v[44:47], v17 offset:62464
    v_mov_b32 v29, v21
    s_waitcnt lgkmcnt(6)
    v_mfma_f32_32x32x16_bf16 v[184:199], v[64:67], v[108:111], v[184:199]
    ds_read_b128 v[48:51], v18 offset:0
    buffer_load_dwordx4 v[80:83], v1, s[8:11], s56 offen offset:2048 sc1
    v_nop
    v_mfma_f32_32x32x16_bf16 v[200:215], v[68:71], v[108:111], v[200:215]
    ds_read_b128 v[52:55], v18 offset:1024
    v_permlane32_swap_b32 v20, v28
    s_waitcnt lgkmcnt(6)
    v_mfma_f32_32x32x16_bf16 v[216:231], v[72:75], v[108:111], v[216:231]
    ds_read_b128 v[56:59], v17 offset:59392
    v_permlane32_swap_b32 v21, v29
    v_mfma_f32_32x32x16_bf16 v[232:247], v[76:79], v[108:111], v[232:247]
    ds_read_b128 v[60:63], v17 offset:60416
    v_add_f32 v20, v20, v28
    s_waitcnt vmcnt(10)
    s_waitcnt lgkmcnt(6)
    v_mfma_f32_32x32x16_bf16 v[152:167], v[32:35], v[112:115], v[152:167]
    ds_read_b128 v[64:67], v17 offset:63488
    v_add_f32 v21, v21, v29
    v_mfma_f32_32x32x16_bf16 v[168:183], v[36:39], v[112:115], v[168:183]
    ds_read_b128 v[68:71], v17 offset:64512
    v_mul_f32 v20, 0xbb000000, v20
    s_waitcnt lgkmcnt(6)
    v_mfma_f32_32x32x16_bf16 v[184:199], v[40:43], v[112:115], v[184:199]
    ds_read_b128 v[72:75], v18 offset:2048
    buffer_load_dwordx4 v[84:87], v1, s[8:11], s56 offen offset:3072 sc1
    v_mul_f32 v21, 0x3b000000, v21
    v_mfma_f32_32x32x16_bf16 v[200:215], v[44:47], v[112:115], v[200:215]
    ds_read_b128 v[76:79], v18 offset:3072
    v_fma_f32 v21, -v20, v20, v21
    s_waitcnt lgkmcnt(6)
    v_mfma_f32_32x32x16_bf16 v[216:231], v[48:51], v[112:115], v[216:231]
    ds_read_b128 v[32:35], v18 offset:4096
    v_max_f32 v21, 0, v21
    v_mfma_f32_32x32x16_bf16 v[232:247], v[52:55], v[112:115], v[232:247]
    ds_read_b128 v[36:39], v18 offset:5120
    v_add_f32 v21, 0x3727c5ac, v21
    s_waitcnt vmcnt(10)
    s_waitcnt lgkmcnt(6)
    v_mfma_f32_32x32x16_bf16 v[152:167], v[56:59], v[116:119], v[152:167]
    ds_read_b128 v[40:43], v18 offset:8192
    v_rsq_f32 v22, v21
    v_mfma_f32_32x32x16_bf16 v[168:183], v[60:63], v[116:119], v[168:183]
    ds_read_b128 v[44:47], v18 offset:9216
    v_nop
    s_waitcnt lgkmcnt(6)
    v_mfma_f32_32x32x16_bf16 v[184:199], v[64:67], v[116:119], v[184:199]
    ds_read_b128 v[48:51], v18 offset:12288
    s_add_u32 s56, s57, 20480
    buffer_load_dwordx4 v[88:91], v1, s[8:11], s56 offen sc1
    v_mul_f32 v23, v22, v22
    v_mfma_f32_32x32x16_bf16 v[200:215], v[68:71], v[116:119], v[200:215]
    ds_read_b128 v[52:55], v18 offset:13312
    v_mul_f32 v24, 0xc0135761, v22
    s_waitcnt lgkmcnt(6)
    v_mfma_f32_32x32x16_bf16 v[216:231], v[72:75], v[116:119], v[216:231]
    ds_read_b128 v[56:59], v18 offset:6144
    v_mul_f32 v25, v23, v22
    v_mfma_f32_32x32x16_bf16 v[232:247], v[76:79], v[116:119], v[232:247]
    ds_read_b128 v[60:63], v18 offset:7168
    v_mul_f32 v25, 0xbdd2d3e8, v25
    s_waitcnt vmcnt(10)
    s_waitcnt lgkmcnt(6)
    v_mfma_f32_32x32x16_bf16 v[152:167], v[32:35], v[120:123], v[152:167]
    ds_read_b128 v[64:67], v18 offset:10240
    v_mfma_f32_32x32x16_bf16 v[168:183], v[36:39], v[120:123], v[168:183]
    ds_read_b128 v[68:71], v18 offset:11264
    s_waitcnt lgkmcnt(6)
    v_mfma_f32_32x32x16_bf16 v[184:199], v[40:43], v[120:123], v[184:199]
    ds_read_b128 v[72:75], v18 offset:14336
    buffer_load_dwordx4 v[92:95], v1, s[8:11], s56 offen offset:1024 sc1
    v_mfma_f32_32x32x16_bf16 v[200:215], v[44:47], v[120:123], v[200:215]
    ds_read_b128 v[76:79], v18 offset:15360
    s_barrier
    s_waitcnt lgkmcnt(6)
    v_mfma_f32_32x32x16_bf16 v[216:231], v[48:51], v[120:123], v[216:231]
    ds_read_b128 v[32:35], v16 offset:0
    v_mfma_f32_32x32x16_bf16 v[232:247], v[52:55], v[120:123], v[232:247]
    ds_read_b128 v[36:39], v16 offset:1024
    s_waitcnt vmcnt(10)
    s_waitcnt lgkmcnt(6)
    v_mfma_f32_32x32x16_bf16 v[152:167], v[56:59], v[124:127], v[152:167]
    ds_read_b128 v[40:43], v16 offset:4096
    v_mfma_f32_32x32x16_bf16 v[168:183], v[60:63], v[124:127], v[168:183]
    ds_read_b128 v[44:47], v16 offset:5120
    s_waitcnt lgkmcnt(6)
    v_mfma_f32_32x32x16_bf16 v[184:199], v[64:67], v[124:127], v[184:199]
    ds_read_b128 v[48:51], v16 offset:8192
    buffer_load_dwordx4 v[96:99], v1, s[8:11], s56 offen offset:2048 sc1
    v_mfma_f32_32x32x16_bf16 v[200:215], v[68:71], v[124:127], v[200:215]
    ds_read_b128 v[52:55], v16 offset:9216
    s_waitcnt lgkmcnt(6)
    v_mfma_f32_32x32x16_bf16 v[216:231], v[72:75], v[124:127], v[216:231]
    ds_read_b128 v[56:59], v16 offset:2048
    v_mfma_f32_32x32x16_bf16 v[232:247], v[76:79], v[124:127], v[232:247]
    ds_read_b128 v[60:63], v16 offset:3072
    s_waitcnt vmcnt(10)
    s_waitcnt lgkmcnt(6)
    v_mfma_f32_32x32x16_bf16 v[152:167], v[32:35], v[128:131], v[152:167]
    ds_read_b128 v[64:67], v16 offset:6144
    v_mfma_f32_32x32x16_bf16 v[168:183], v[36:39], v[128:131], v[168:183]
    ds_read_b128 v[68:71], v16 offset:7168
    s_waitcnt lgkmcnt(6)
    v_mfma_f32_32x32x16_bf16 v[184:199], v[40:43], v[128:131], v[184:199]
    ds_read_b128 v[72:75], v16 offset:10240
    buffer_load_dwordx4 v[100:103], v1, s[8:11], s56 offen offset:3072 sc1
    v_mfma_f32_32x32x16_bf16 v[200:215], v[44:47], v[128:131], v[200:215]
    ds_read_b128 v[76:79], v16 offset:11264
    s_waitcnt lgkmcnt(6)
    v_mfma_f32_32x32x16_bf16 v[216:231], v[48:51], v[128:131], v[216:231]
    ds_read_b128 v[32:35], v16 offset:12288
    v_mfma_f32_32x32x16_bf16 v[232:247], v[52:55], v[128:131], v[232:247]
    ds_read_b128 v[36:39], v16 offset:13312
    s_waitcnt vmcnt(10)
    s_waitcnt lgkmcnt(6)
    v_mfma_f32_32x32x16_bf16 v[152:167], v[56:59], v[132:135], v[152:167]
    ds_read_b128 v[40:43], v16 offset:16384
    v_mfma_f32_32x32x16_bf16 v[168:183], v[60:63], v[132:135], v[168:183]
    ds_read_b128 v[44:47], v16 offset:17408
    s_waitcnt lgkmcnt(6)
    v_mfma_f32_32x32x16_bf16 v[184:199], v[64:67], v[132:135], v[184:199]
    ds_read_b128 v[48:51], v16 offset:20480
    s_add_u32 s56, s57, 24576
    buffer_load_dwordx4 v[104:107], v1, s[8:11], s56 offen sc1
    v_mfma_f32_32x32x16_bf16 v[200:215], v[68:71], v[132:135], v[200:215]
    ds_read_b128 v[52:55], v16 offset:21504
    s_waitcnt lgkmcnt(6)
    v_mfma_f32_32x32x16_bf16 v[216:231], v[72:75], v[132:135], v[216:231]
    ds_read_b128 v[56:59], v16 offset:14336
    v_mfma_f32_32x32x16_bf16 v[232:247], v[76:79], v[132:135], v[232:247]
    ds_read_b128 v[60:63], v16 offset:15360
    s_waitcnt vmcnt(10)
    s_waitcnt lgkmcnt(6)
    v_mfma_f32_32x32x16_bf16 v[152:167], v[32:35], v[136:139], v[152:167]
    ds_read_b128 v[64:67], v16 offset:18432
    v_mfma_f32_32x32x16_bf16 v[168:183], v[36:39], v[136:139], v[168:183]
    ds_read_b128 v[68:71], v16 offset:19456
    s_waitcnt lgkmcnt(6)
    v_mfma_f32_32x32x16_bf16 v[184:199], v[40:43], v[136:139], v[184:199]
    ds_read_b128 v[72:75], v16 offset:22528
    buffer_load_dwordx4 v[108:111], v1, s[8:11], s56 offen offset:1024 sc1
    v_mfma_f32_32x32x16_bf16 v[200:215], v[44:47], v[136:139], v[200:215]
    ds_read_b128 v[76:79], v16 offset:23552
    s_barrier
    s_waitcnt lgkmcnt(6)
    v_mfma_f32_32x32x16_bf16 v[216:231], v[48:51], v[136:139], v[216:231]
    ds_read_b128 v[32:35], v16 offset:24576
    v_mfma_f32_32x32x16_bf16 v[232:247], v[52:55], v[136:139], v[232:247]
    ds_read_b128 v[36:39], v16 offset:25600
    s_waitcnt vmcnt(10)
    s_waitcnt lgkmcnt(6)
    v_mfma_f32_32x32x16_bf16 v[152:167], v[56:59], v[140:143], v[152:167]
    ds_read_b128 v[40:43], v16 offset:28672
    v_mfma_f32_32x32x16_bf16 v[168:183], v[60:63], v[140:143], v[168:183]
    ds_read_b128 v[44:47], v16 offset:29696
    s_waitcnt lgkmcnt(6)
    v_mfma_f32_32x32x16_bf16 v[184:199], v[64:67], v[140:143], v[184:199]
    ds_read_b128 v[48:51], v16 offset:32768
    buffer_load_dwordx4 v[112:115], v1, s[8:11], s56 offen offset:2048 sc1
    v_mfma_f32_32x32x16_bf16 v[200:215], v[68:71], v[140:143], v[200:215]
    ds_read_b128 v[52:55], v16 offset:33792
    s_waitcnt lgkmcnt(6)
    v_mfma_f32_32x32x16_bf16 v[216:231], v[72:75], v[140:143], v[216:231]
    ds_read_b128 v[56:59], v16 offset:26624
    v_mfma_f32_32x32x16_bf16 v[232:247], v[76:79], v[140:143], v[232:247]
    ds_read_b128 v[60:63], v16 offset:27648
    s_waitcnt vmcnt(10)
    s_waitcnt lgkmcnt(6)
    v_mfma_f32_32x32x16_bf16 v[152:167], v[32:35], v[144:147], v[152:167]
    ds_read_b128 v[64:67], v16 offset:30720
    v_mfma_f32_32x32x16_bf16 v[168:183], v[36:39], v[144:147], v[168:183]
    ds_read_b128 v[68:71], v16 offset:31744
    s_waitcnt lgkmcnt(6)
    v_mfma_f32_32x32x16_bf16 v[184:199], v[40:43], v[144:147], v[184:199]
    ds_read_b128 v[72:75], v16 offset:34816
    buffer_load_dwordx4 v[116:119], v1, s[8:11], s56 offen offset:3072 sc1
    v_mfma_f32_32x32x16_bf16 v[200:215], v[44:47], v[144:147], v[200:215]
    ds_read_b128 v[76:79], v16 offset:35840
    s_waitcnt lgkmcnt(6)
    v_mfma_f32_32x32x16_bf16 v[216:231], v[48:51], v[144:147], v[216:231]
    ds_read_b128 v[32:35], v16 offset:36864
    v_mfma_f32_32x32x16_bf16 v[232:247], v[52:55], v[144:147], v[232:247]
    ds_read_b128 v[36:39], v16 offset:37888
    s_waitcnt vmcnt(10)
    s_waitcnt lgkmcnt(6)
    v_mfma_f32_32x32x16_bf16 v[152:167], v[56:59], v[148:151], v[152:167]
    ds_read_b128 v[40:43], v16 offset:40960
    v_mfma_f32_32x32x16_bf16 v[168:183], v[60:63], v[148:151], v[168:183]
    ds_read_b128 v[44:47], v16 offset:41984
    s_waitcnt lgkmcnt(6)
    v_mfma_f32_32x32x16_bf16 v[184:199], v[64:67], v[148:151], v[184:199]
    ds_read_b128 v[48:51], v16 offset:45056
    s_add_u32 s56, s57, 28672
    buffer_load_dwordx4 v[120:123], v1, s[8:11], s56 offen sc1
    v_mfma_f32_32x32x16_bf16 v[200:215], v[68:71], v[148:151], v[200:215]
    ds_read_b128 v[52:55], v16 offset:46080
    s_waitcnt lgkmcnt(6)
    v_mfma_f32_32x32x16_bf16 v[216:231], v[72:75], v[148:151], v[216:231]
    ds_read_b128 v[56:59], v16 offset:38912
    v_mfma_f32_32x32x16_bf16 v[232:247], v[76:79], v[148:151], v[232:247]
    ds_read_b128 v[60:63], v16 offset:39936
    s_waitcnt vmcnt(10)
    s_waitcnt lgkmcnt(6)
    v_mfma_f32_32x32x16_bf16 v[152:167], v[32:35], v[80:83], v[152:167]
    ds_read_b128 v[64:67], v16 offset:43008
    v_mfma_f32_32x32x16_bf16 v[168:183], v[36:39], v[80:83], v[168:183]
    ds_read_b128 v[68:71], v16 offset:44032
    s_waitcnt lgkmcnt(6)
    v_mfma_f32_32x32x16_bf16 v[184:199], v[40:43], v[80:83], v[184:199]
    ds_read_b128 v[72:75], v16 offset:47104
    buffer_load_dwordx4 v[124:127], v1, s[8:11], s56 offen offset:1024 sc1
    v_mfma_f32_32x32x16_bf16 v[200:215], v[44:47], v[80:83], v[200:215]
    ds_read_b128 v[76:79], v16 offset:48128
    s_barrier
    s_waitcnt lgkmcnt(6)
    v_mfma_f32_32x32x16_bf16 v[216:231], v[48:51], v[80:83], v[216:231]
    ds_read_b128 v[32:35], v16 offset:49152
    v_mfma_f32_32x32x16_bf16 v[232:247], v[52:55], v[80:83], v[232:247]
    ds_read_b128 v[36:39], v16 offset:50176
    s_waitcnt vmcnt(10)
    s_waitcnt lgkmcnt(6)
    v_mfma_f32_32x32x16_bf16 v[152:167], v[56:59], v[84:87], v[152:167]
    ds_read_b128 v[40:43], v16 offset:53248
    v_mfma_f32_32x32x16_bf16 v[168:183], v[60:63], v[84:87], v[168:183]
    ds_read_b128 v[44:47], v16 offset:54272
    s_waitcnt lgkmcnt(6)
    v_mfma_f32_32x32x16_bf16 v[184:199], v[64:67], v[84:87], v[184:199]
    ds_read_b128 v[48:51], v16 offset:57344
    buffer_load_dwordx4 v[128:131], v1, s[8:11], s56 offen offset:2048 sc1
    v_mfma_f32_32x32x16_bf16 v[200:215], v[68:71], v[84:87], v[200:215]
    ds_read_b128 v[52:55], v16 offset:58368
    s_waitcnt lgkmcnt(6)
    v_mfma_f32_32x32x16_bf16 v[216:231], v[72:75], v[84:87], v[216:231]
    ds_read_b128 v[56:59], v16 offset:51200
    v_mfma_f32_32x32x16_bf16 v[232:247], v[76:79], v[84:87], v[232:247]
    ds_read_b128 v[60:63], v16 offset:52224
    s_waitcnt vmcnt(10)
    s_waitcnt lgkmcnt(6)
    v_mfma_f32_32x32x16_bf16 v[152:167], v[32:35], v[88:91], v[152:167]
    ds_read_b128 v[64:67], v16 offset:55296
    v_mfma_f32_32x32x16_bf16 v[168:183], v[36:39], v[88:91], v[168:183]
    ds_read_b128 v[68:71], v16 offset:56320
    s_waitcnt lgkmcnt(6)
    v_mfma_f32_32x32x16_bf16 v[184:199], v[40:43], v[88:91], v[184:199]
    ds_read_b128 v[72:75], v16 offset:59392
    buffer_load_dwordx4 v[132:135], v1, s[8:11], s56 offen offset:3072 sc1
    v_mfma_f32_32x32x16_bf16 v[200:215], v[44:47], v[88:91], v[200:215]
    ds_read_b128 v[76:79], v16 offset:60416
    s_waitcnt lgkmcnt(6)
    v_mfma_f32_32x32x16_bf16 v[216:231], v[48:51], v[88:91], v[216:231]
    ds_read_b128 v[32:35], v16 offset:61440
    v_mfma_f32_32x32x16_bf16 v[232:247], v[52:55], v[88:91], v[232:247]
    ds_read_b128 v[36:39], v16 offset:62464
    s_waitcnt vmcnt(10)
    s_waitcnt lgkmcnt(6)
    v_mfma_f32_32x32x16_bf16 v[152:167], v[56:59], v[92:95], v[152:167]
    ds_read_b128 v[40:43], v17 offset:0
    v_mfma_f32_32x32x16_bf16 v[168:183], v[60:63], v[92:95], v[168:183]
    ds_read_b128 v[44:47], v17 offset:1024
    s_waitcnt lgkmcnt(6)
    v_mfma_f32_32x32x16_bf16 v[184:199], v[64:67], v[92:95], v[184:199]
    ds_read_b128 v[48:51], v17 offset:4096
    v_mfma_f32_32x32x16_bf16 v[200:215], v[68:71], v[92:95], v[200:215]
    ds_read_b128 v[52:55], v17 offset:5120
    s_waitcnt lgkmcnt(6)
    v_mfma_f32_32x32x16_bf16 v[216:231], v[72:75], v[92:95], v[216:231]
    ds_read_b128 v[56:59], v16 offset:63488
    v_mfma_f32_32x32x16_bf16 v[232:247], v[76:79], v[92:95], v[232:247]
    ds_read_b128 v[60:63], v16 offset:64512
    s_waitcnt vmcnt(9)
    s_waitcnt lgkmcnt(6)
    v_mfma_f32_32x32x16_bf16 v[152:167], v[32:35], v[96:99], v[152:167]
    ds_read_b128 v[64:67], v17 offset:2048
    v_mfma_f32_32x32x16_bf16 v[168:183], v[36:39], v[96:99], v[168:183]
    ds_read_b128 v[68:71], v17 offset:3072
    s_waitcnt lgkmcnt(6)
    v_mfma_f32_32x32x16_bf16 v[184:199], v[40:43], v[96:99], v[184:199]
    ds_read_b128 v[72:75], v17 offset:6144
    v_mfma_f32_32x32x16_bf16 v[200:215], v[44:47], v[96:99], v[200:215]
    ds_read_b128 v[76:79], v17 offset:7168
    s_barrier
    s_waitcnt lgkmcnt(6)
    v_mfma_f32_32x32x16_bf16 v[216:231], v[48:51], v[96:99], v[216:231]
    ds_read_b128 v[32:35], v17 offset:8192
    v_mfma_f32_32x32x16_bf16 v[232:247], v[52:55], v[96:99], v[232:247]
    ds_read_b128 v[36:39], v17 offset:9216
    s_waitcnt vmcnt(8)
    s_waitcnt lgkmcnt(6)
    v_mfma_f32_32x32x16_bf16 v[152:167], v[56:59], v[100:103], v[152:167]
    ds_read_b128 v[40:43], v17 offset:12288
    v_mfma_f32_32x32x16_bf16 v[168:183], v[60:63], v[100:103], v[168:183]
    ds_read_b128 v[44:47], v17 offset:13312
    s_waitcnt lgkmcnt(6)
    v_mfma_f32_32x32x16_bf16 v[184:199], v[64:67], v[100:103], v[184:199]
    ds_read_b128 v[48:51], v17 offset:16384
    v_mfma_f32_32x32x16_bf16 v[200:215], v[68:71], v[100:103], v[200:215]
    ds_read_b128 v[52:55], v17 offset:17408
    s_waitcnt lgkmcnt(6)
    v_mfma_f32_32x32x16_bf16 v[216:231], v[72:75], v[100:103], v[216:231]
    ds_read_b128 v[56:59], v17 offset:10240
    v_mfma_f32_32x32x16_bf16 v[232:247], v[76:79], v[100:103], v[232:247]
    ds_read_b128 v[60:63], v17 offset:11264
    s_waitcnt vmcnt(7)
    s_waitcnt lgkmcnt(6)
    v_mfma_f32_32x32x16_bf16 v[152:167], v[32:35], v[104:107], v[152:167]
    ds_read_b128 v[64:67], v17 offset:14336
    v_mfma_f32_32x32x16_bf16 v[168:183], v[36:39], v[104:107], v[168:183]
    ds_read_b128 v[68:71], v17 offset:15360
    s_waitcnt lgkmcnt(6)
    v_mfma_f32_32x32x16_bf16 v[184:199], v[40:43], v[104:107], v[184:199]
    ds_read_b128 v[72:75], v17 offset:18432
    v_mfma_f32_32x32x16_bf16 v[200:215], v[44:47], v[104:107], v[200:215]
    ds_read_b128 v[76:79], v17 offset:19456
    s_waitcnt lgkmcnt(6)
    v_mfma_f32_32x32x16_bf16 v[216:231], v[48:51], v[104:107], v[216:231]
    ds_read_b128 v[32:35], v17 offset:20480
    v_mfma_f32_32x32x16_bf16 v[232:247], v[52:55], v[104:107], v[232:247]
    ds_read_b128 v[36:39], v17 offset:21504
    s_waitcnt vmcnt(6)
    s_waitcnt lgkmcnt(6)
    v_mfma_f32_32x32x16_bf16 v[152:167], v[56:59], v[108:111], v[152:167]
    ds_read_b128 v[40:43], v17 offset:24576
    v_mfma_f32_32x32x16_bf16 v[168:183], v[60:63], v[108:111], v[168:183]
    ds_read_b128 v[44:47], v17 offset:25600
    s_waitcnt lgkmcnt(6)
    v_mfma_f32_32x32x16_bf16 v[184:199], v[64:67], v[108:111], v[184:199]
    ds_read_b128 v[48:51], v17 offset:28672
    v_mfma_f32_32x32x16_bf16 v[200:215], v[68:71], v[108:111], v[200:215]
    ds_read_b128 v[52:55], v17 offset:29696
    s_waitcnt lgkmcnt(6)
    v_mfma_f32_32x32x16_bf16 v[216:231], v[72:75], v[108:111], v[216:231]
    ds_read_b128 v[56:59], v17 offset:22528
    v_mfma_f32_32x32x16_bf16 v[232:247], v[76:79], v[108:111], v[232:247]
    ds_read_b128 v[60:63], v17 offset:23552
    s_waitcnt vmcnt(5)
    s_waitcnt lgkmcnt(6)
    v_mfma_f32_32x32x16_bf16 v[152:167], v[32:35], v[112:115], v[152:167]
    ds_read_b128 v[64:67], v17 offset:26624
    v_mfma_f32_32x32x16_bf16 v[168:183], v[36:39], v[112:115], v[168:183]
    ds_read_b128 v[68:71], v17 offset:27648
    s_waitcnt lgkmcnt(6)
    v_mfma_f32_32x32x16_bf16 v[184:199], v[40:43], v[112:115], v[184:199]
    ds_read_b128 v[72:75], v17 offset:30720
    v_mfma_f32_32x32x16_bf16 v[200:215], v[44:47], v[112:115], v[200:215]
    ds_read_b128 v[76:79], v17 offset:31744
    s_barrier
    s_waitcnt lgkmcnt(6)
    v_mfma_f32_32x32x16_bf16 v[216:231], v[48:51], v[112:115], v[216:231]
    ds_read_b128 v[32:35], v17 offset:32768
    v_mfma_f32_32x32x16_bf16 v[232:247], v[52:55], v[112:115], v[232:247]
    ds_read_b128 v[36:39], v17 offset:33792
    s_waitcnt vmcnt(4)
    s_waitcnt lgkmcnt(6)
    v_mfma_f32_32x32x16_bf16 v[152:167], v[56:59], v[116:119], v[152:167]
    ds_read_b128 v[40:43], v17 offset:36864
    v_mfma_f32_32x32x16_bf16 v[168:183], v[60:63], v[116:119], v[168:183]
    ds_read_b128 v[44:47], v17 offset:37888
    s_waitcnt lgkmcnt(6)
    v_mfma_f32_32x32x16_bf16 v[184:199], v[64:67], v[116:119], v[184:199]
    ds_read_b128 v[48:51], v17 offset:40960
    v_mfma_f32_32x32x16_bf16 v[200:215], v[68:71], v[116:119], v[200:215]
    ds_read_b128 v[52:55], v17 offset:41984
    s_waitcnt lgkmcnt(6)
    v_mfma_f32_32x32x16_bf16 v[216:231], v[72:75], v[116:119], v[216:231]
    ds_read_b128 v[56:59], v17 offset:34816
    v_mfma_f32_32x32x16_bf16 v[232:247], v[76:79], v[116:119], v[232:247]
    ds_read_b128 v[60:63], v17 offset:35840
    s_waitcnt vmcnt(3)
    s_waitcnt lgkmcnt(6)
    v_mfma_f32_32x32x16_bf16 v[152:167], v[32:35], v[120:123], v[152:167]
    ds_read_b128 v[64:67], v17 offset:38912
    v_mfma_f32_32x32x16_bf16 v[168:183], v[36:39], v[120:123], v[168:183]
    ds_read_b128 v[68:71], v17 offset:39936
    s_waitcnt lgkmcnt(6)
    v_mfma_f32_32x32x16_bf16 v[184:199], v[40:43], v[120:123], v[184:199]
    ds_read_b128 v[72:75], v17 offset:43008
    v_mfma_f32_32x32x16_bf16 v[200:215], v[44:47], v[120:123], v[200:215]
    ds_read_b128 v[76:79], v17 offset:44032
    s_waitcnt lgkmcnt(6)
    v_mfma_f32_32x32x16_bf16 v[216:231], v[48:51], v[120:123], v[216:231]
    ds_read_b128 v[32:35], v17 offset:45056
    v_mfma_f32_32x32x16_bf16 v[232:247], v[52:55], v[120:123], v[232:247]
    ds_read_b128 v[36:39], v17 offset:46080
    s_waitcnt vmcnt(2)
    s_waitcnt lgkmcnt(6)
    v_mfma_f32_32x32x16_bf16 v[152:167], v[56:59], v[124:127], v[152:167]
    ds_read_b128 v[40:43], v17 offset:49152
    v_mfma_f32_32x32x16_bf16 v[168:183], v[60:63], v[124:127], v[168:183]
    ds_read_b128 v[44:47], v17 offset:50176
    s_waitcnt lgkmcnt(6)
    v_mfma_f32_32x32x16_bf16 v[184:199], v[64:67], v[124:127], v[184:199]
    ds_read_b128 v[48:51], v17 offset:53248
    v_mfma_f32_32x32x16_bf16 v[200:215], v[68:71], v[124:127], v[200:215]
    ds_read_b128 v[52:55], v17 offset:54272
    s_waitcnt lgkmcnt(6)
    v_mfma_f32_32x32x16_bf16 v[216:231], v[72:75], v[124:127], v[216:231]
    ds_read_b128 v[56:59], v17 offset:47104
    v_mfma_f32_32x32x16_bf16 v[232:247], v[76:79], v[124:127], v[232:247]
    ds_read_b128 v[60:63], v17 offset:48128
    s_waitcnt vmcnt(1)
    s_waitcnt lgkmcnt(6)
    v_mfma_f32_32x32x16_bf16 v[152:167], v[32:35], v[128:131], v[152:167]
    ds_read_b128 v[64:67], v17 offset:51200
    v_mfma_f32_32x32x16_bf16 v[168:183], v[36:39], v[128:131], v[168:183]
    ds_read_b128 v[68:71], v17 offset:52224
    s_waitcnt lgkmcnt(6)
    v_mfma_f32_32x32x16_bf16 v[184:199], v[40:43], v[128:131], v[184:199]
    ds_read_b128 v[72:75], v17 offset:55296
    v_mfma_f32_32x32x16_bf16 v[200:215], v[44:47], v[128:131], v[200:215]
    ds_read_b128 v[76:79], v17 offset:56320
    s_waitcnt lgkmcnt(6)
    v_mfma_f32_32x32x16_bf16 v[216:231], v[48:51], v[128:131], v[216:231]
    v_mfma_f32_32x32x16_bf16 v[232:247], v[52:55], v[128:131], v[232:247]
    s_waitcnt vmcnt(0)
    s_waitcnt lgkmcnt(4)
    v_mfma_f32_32x32x16_bf16 v[152:167], v[56:59], v[132:135], v[152:167]
    v_mfma_f32_32x32x16_bf16 v[168:183], v[60:63], v[132:135], v[168:183]
    s_waitcnt lgkmcnt(2)
    v_mfma_f32_32x32x16_bf16 v[184:199], v[64:67], v[132:135], v[184:199]
    v_mfma_f32_32x32x16_bf16 v[200:215], v[68:71], v[132:135], v[200:215]
    s_waitcnt lgkmcnt(0)
    v_mfma_f32_32x32x16_bf16 v[216:231], v[72:75], v[132:135], v[216:231]
    v_mfma_f32_32x32x16_bf16 v[232:247], v[76:79], v[132:135], v[232:247]
    s_waitcnt lgkmcnt(0)
    s_barrier
    v_bfe_u32 v28, v15, 4, 1
    v_mul_u32_u24 v28, 44032, v28
    v_lshrrev_b32 v29, 5, v15
    v_lshl_add_u32 v28, v29, 8, v28
    v_lshlrev_b32 v29, 6, v29
    v_add_u32 v31, 156672, v29
    v_and_b32 v29, 15, v15
    v_lshl_add_u32 v30, v29, 4, v28
    s_lshl_b32 s54, s82, 1
    s_mul_i32 s54, s54, 43
    s_add_u32 s54, s54, s80
    s_lshl_b32 s54, s54, 10
    s_add_u32 s54, s54, s50
    s_add_u32 s54, s54, 12582912
    ds_read_b128 v[32:35], v31 offset:0
    ds_read_b128 v[36:39], v31 offset:16
    ds_read_b128 v[40:43], v31 offset:32
    ds_read_b128 v[44:47], v31 offset:48
    ds_read_b128 v[48:51], v31 offset:128
    ds_read_b128 v[52:55], v31 offset:144
    ds_read_b128 v[56:59], v31 offset:160
    ds_read_b128 v[60:63], v31 offset:176
    ds_read_b128 v[64:67], v31 offset:256
    ds_read_b128 v[68:71], v31 offset:272
    ds_read_b128 v[72:75], v31 offset:288
    ds_read_b128 v[76:79], v31 offset:304
    ds_read_b128 v[80:83], v31 offset:384
    ds_read_b128 v[84:87], v31 offset:400
    ds_read_b128 v[88:91], v31 offset:416
    ds_read_b128 v[92:95], v31 offset:432
    s_waitcnt lgkmcnt(15)
    v_pk_fma_f32 v[152:153], v[32:33], v[20:21], v[152:153] op_sel:[0,0,0] op_sel_hi:[1,0,1]
    v_pk_fma_f32 v[154:155], v[34:35], v[20:21], v[154:155] op_sel:[0,0,0] op_sel_hi:[1,0,1]
    s_waitcnt lgkmcnt(14)
    v_pk_fma_f32 v[156:157], v[36:37], v[20:21], v[156:157] op_sel:[0,0,0] op_sel_hi:[1,0,1]
    v_pk_fma_f32 v[158:159], v[38:39], v[20:21], v[158:159] op_sel:[0,0,0] op_sel_hi:[1,0,1]
    s_waitcnt lgkmcnt(13)
    v_pk_fma_f32 v[160:161], v[40:41], v[20:21], v[160:161] op_sel:[0,0,0] op_sel_hi:[1,0,1]
    v_pk_fma_f32 v[162:163], v[42:43], v[20:21], v[162:163] op_sel:[0,0,0] op_sel_hi:[1,0,1]
    s_waitcnt lgkmcnt(12)
    v_pk_fma_f32 v[164:165], v[44:45], v[20:21], v[164:165] op_sel:[0,0,0] op_sel_hi:[1,0,1]
    v_pk_fma_f32 v[166:167], v[46:47], v[20:21], v[166:167] op_sel:[0,0,0] op_sel_hi:[1,0,1]
    s_waitcnt lgkmcnt(11)
    v_pk_fma_f32 v[168:169], v[48:49], v[20:21], v[168:169] op_sel:[0,0,0] op_sel_hi:[1,0,1]
    v_pk_fma_f32 v[170:171], v[50:51], v[20:21], v[170:171] op_sel:[0,0,0] op_sel_hi:[1,0,1]
    s_waitcnt lgkmcnt(10)
    v_pk_fma_f32 v[172:173], v[52:53], v[20:21], v[172:173] op_sel:[0,0,0] op_sel_hi:[1,0,1]
    v_pk_fma_f32 v[174:175], v[54:55], v[20:21], v[174:175] op_sel:[0,0,0] op_sel_hi:[1,0,1]
    s_waitcnt lgkmcnt(9)
    v_pk_fma_f32 v[176:177], v[56:57], v[20:21], v[176:177] op_sel:[0,0,0] op_sel_hi:[1,0,1]
    v_pk_fma_f32 v[178:179], v[58:59], v[20:21], v[178:179] op_sel:[0,0,0] op_sel_hi:[1,0,1]
    s_waitcnt lgkmcnt(8)
    v_pk_fma_f32 v[180:181], v[60:61], v[20:21], v[180:181] op_sel:[0,0,0] op_sel_hi:[1,0,1]
    v_pk_fma_f32 v[182:183], v[62:63], v[20:21], v[182:183] op_sel:[0,0,0] op_sel_hi:[1,0,1]
    v_pk_mul_f32 v[120:121], v[152:153], v[152:153]
    v_pk_mul_f32 v[128:129], v[154:155], v[154:155]
    v_pk_mul_f32 v[136:137], v[156:157], v[156:157]
    v_pk_mul_f32 v[144:145], v[158:159], v[158:159]
    v_pk_fma_f32 v[120:121], v[120:121], v[24:25], v[24:25] op_sel:[0,1,0] op_sel_hi:[1,1,0]
    v_pk_fma_f32 v[128:129], v[128:129], v[24:25], v[24:25] op_sel:[0,1,0] op_sel_hi:[1,1,0]
    v_pk_fma_f32 v[136:137], v[136:137], v[24:25], v[24:25] op_sel:[0,1,0] op_sel_hi:[1,1,0]
    v_pk_fma_f32 v[144:145], v[144:145], v[24:25], v[24:25] op_sel:[0,1,0] op_sel_hi:[1,1,0]
    v_pk_mul_f32 v[120:121], v[120:121], v[152:153]
    v_pk_mul_f32 v[128:129], v[128:129], v[154:155]
    v_pk_mul_f32 v[136:137], v[136:137], v[156:157]
    v_pk_mul_f32 v[144:145], v[144:145], v[158:159]
    v_exp_f32 v120, v120
    v_exp_f32 v121, v121
    v_exp_f32 v128, v128
    v_exp_f32 v129, v129
    v_exp_f32 v136, v136
    v_exp_f32 v137, v137
    v_exp_f32 v144, v144
    v_exp_f32 v145, v145
    v_pk_mul_f32 v[122:123], v[152:153], v[168:169]
    v_pk_mul_f32 v[130:131], v[154:155], v[170:171]
    v_pk_mul_f32 v[138:139], v[156:157], v[172:173]
    v_pk_mul_f32 v[146:147], v[158:159], v[174:175]
    v_pk_add_f32 v[120:121], v[120:121], s[86:87]
    v_pk_add_f32 v[128:129], v[128:129], s[86:87]
    v_pk_add_f32 v[136:137], v[136:137], s[86:87]
    v_pk_add_f32 v[144:145], v[144:145], s[86:87]
    v_pk_mul_f32 v[122:123], v[122:123], v[22:23] op_sel:[0,1] op_sel_hi:[1,1]
    v_pk_mul_f32 v[130:131], v[130:131], v[22:23] op_sel:[0,1] op_sel_hi:[1,1]
    v_pk_mul_f32 v[138:139], v[138:139], v[22:23] op_sel:[0,1] op_sel_hi:[1,1]
    v_pk_mul_f32 v[146:147], v[146:147], v[22:23] op_sel:[0,1] op_sel_hi:[1,1]
    v_rcp_f32 v120, v120
    v_rcp_f32 v121, v121
    v_rcp_f32 v128, v128
    v_rcp_f32 v129, v129
    v_rcp_f32 v136, v136
    v_rcp_f32 v137, v137
    v_rcp_f32 v144, v144
    v_rcp_f32 v145, v145
    v_pk_mul_f32 v[122:123], v[122:123], v[120:121]
    v_pk_mul_f32 v[130:131], v[130:131], v[128:129]
    v_pk_mul_f32 v[138:139], v[138:139], v[136:137]
    v_pk_mul_f32 v[146:147], v[146:147], v[144:145]
    v_cvt_pk_bf16_f32 v96, v122, v123
    v_cvt_pk_bf16_f32 v97, v130, v131
    v_cvt_pk_bf16_f32 v98, v138, v139
    v_cvt_pk_bf16_f32 v99, v146, v147
    v_pk_mul_f32 v[120:121], v[160:161], v[160:161]
    v_pk_mul_f32 v[128:129], v[162:163], v[162:163]
    v_pk_mul_f32 v[136:137], v[164:165], v[164:165]
    v_pk_mul_f32 v[144:145], v[166:167], v[166:167]
    v_pk_fma_f32 v[120:121], v[120:121], v[24:25], v[24:25] op_sel:[0,1,0] op_sel_hi:[1,1,0]
    v_pk_fma_f32 v[128:129], v[128:129], v[24:25], v[24:25] op_sel:[0,1,0] op_sel_hi:[1,1,0]
    v_pk_fma_f32 v[136:137], v[136:137], v[24:25], v[24:25] op_sel:[0,1,0] op_sel_hi:[1,1,0]
    v_pk_fma_f32 v[144:145], v[144:145], v[24:25], v[24:25] op_sel:[0,1,0] op_sel_hi:[1,1,0]
    v_pk_mul_f32 v[120:121], v[120:121], v[160:161]
    v_pk_mul_f32 v[128:129], v[128:129], v[162:163]
    v_pk_mul_f32 v[136:137], v[136:137], v[164:165]
    v_pk_mul_f32 v[144:145], v[144:145], v[166:167]
    v_exp_f32 v120, v120
    v_exp_f32 v121, v121
    v_exp_f32 v128, v128
    v_exp_f32 v129, v129
    v_exp_f32 v136, v136
    v_exp_f32 v137, v137
    v_exp_f32 v144, v144
    v_exp_f32 v145, v145
    v_pk_mul_f32 v[122:123], v[160:161], v[176:177]
    v_pk_mul_f32 v[130:131], v[162:163], v[178:179]
    v_pk_mul_f32 v[138:139], v[164:165], v[180:181]
    v_pk_mul_f32 v[146:147], v[166:167], v[182:183]
    v_pk_add_f32 v[120:121], v[120:121], s[86:87]
    v_pk_add_f32 v[128:129], v[128:129], s[86:87]
    v_pk_add_f32 v[136:137], v[136:137], s[86:87]
    v_pk_add_f32 v[144:145], v[144:145], s[86:87]
    v_pk_mul_f32 v[122:123], v[122:123], v[22:23] op_sel:[0,1] op_sel_hi:[1,1]
    v_pk_mul_f32 v[130:131], v[130:131], v[22:23] op_sel:[0,1] op_sel_hi:[1,1]
    v_pk_mul_f32 v[138:139], v[138:139], v[22:23] op_sel:[0,1] op_sel_hi:[1,1]
    v_pk_mul_f32 v[146:147], v[146:147], v[22:23] op_sel:[0,1] op_sel_hi:[1,1]
    v_rcp_f32 v120, v120
    v_rcp_f32 v121, v121
    v_rcp_f32 v128, v128
    v_rcp_f32 v129, v129
    v_rcp_f32 v136, v136
    v_rcp_f32 v137, v137
    v_rcp_f32 v144, v144
    v_rcp_f32 v145, v145
    v_pk_mul_f32 v[122:123], v[122:123], v[120:121]
    v_pk_mul_f32 v[130:131], v[130:131], v[128:129]
    v_pk_mul_f32 v[138:139], v[138:139], v[136:137]
    v_pk_mul_f32 v[146:147], v[146:147], v[144:145]
    v_cvt_pk_bf16_f32 v100, v122, v123
    v_cvt_pk_bf16_f32 v101, v130, v131
    v_cvt_pk_bf16_f32 v102, v138, v139
    v_cvt_pk_bf16_f32 v103, v146, v147
    s_nop 7
    s_cmp_eq_u32 s99, 0
    s_cbranch_scc1 L_slow_59
    buffer_store_dwordx4 v[96:99], v30, s[8:11], s54 offen offset:0
    buffer_store_dwordx4 v[100:103], v30, s[8:11], s54 offen offset:512
    s_branch L_join_60
L_slow_59:
    buffer_store_dwordx4 v[96:99], v30, s[8:11], s54 offen offset:0 sc1
    buffer_store_dwordx4 v[100:103], v30, s[8:11], s54 offen offset:512 sc1
L_join_60:
    s_nop 1
    s_waitcnt lgkmcnt(7)
    v_pk_fma_f32 v[184:185], v[64:65], v[20:21], v[184:185] op_sel:[0,0,0] op_sel_hi:[1,0,1]
    v_pk_fma_f32 v[186:187], v[66:67], v[20:21], v[186:187] op_sel:[0,0,0] op_sel_hi:[1,0,1]
    s_waitcnt lgkmcnt(6)
    v_pk_fma_f32 v[188:189], v[68:69], v[20:21], v[188:189] op_sel:[0,0,0] op_sel_hi:[1,0,1]
    v_pk_fma_f32 v[190:191], v[70:71], v[20:21], v[190:191] op_sel:[0,0,0] op_sel_hi:[1,0,1]
    s_waitcnt lgkmcnt(5)
    v_pk_fma_f32 v[192:193], v[72:73], v[20:21], v[192:193] op_sel:[0,0,0] op_sel_hi:[1,0,1]
    v_pk_fma_f32 v[194:195], v[74:75], v[20:21], v[194:195] op_sel:[0,0,0] op_sel_hi:[1,0,1]
    s_waitcnt lgkmcnt(4)
    v_pk_fma_f32 v[196:197], v[76:77], v[20:21], v[196:197] op_sel:[0,0,0] op_sel_hi:[1,0,1]
    v_pk_fma_f32 v[198:199], v[78:79], v[20:21], v[198:199] op_sel:[0,0,0] op_sel_hi:[1,0,1]
    s_waitcnt lgkmcnt(3)
    v_pk_fma_f32 v[200:201], v[80:81], v[20:21], v[200:201] op_sel:[0,0,0] op_sel_hi:[1,0,1]
    v_pk_fma_f32 v[202:203], v[82:83], v[20:21], v[202:203] op_sel:[0,0,0] op_sel_hi:[1,0,1]
    s_waitcnt lgkmcnt(2)
    v_pk_fma_f32 v[204:205], v[84:85], v[20:21], v[204:205] op_sel:[0,0,0] op_sel_hi:[1,0,1]
    v_pk_fma_f32 v[206:207], v[86:87], v[20:21], v[206:207] op_sel:[0,0,0] op_sel_hi:[1,0,1]
    s_waitcnt lgkmcnt(1)
    v_pk_fma_f32 v[208:209], v[88:89], v[20:21], v[208:209] op_sel:[0,0,0] op_sel_hi:[1,0,1]
    v_pk_fma_f32 v[210:211], v[90:91], v[20:21], v[210:211] op_sel:[0,0,0] op_sel_hi:[1,0,1]
    s_waitcnt lgkmcnt(0)
    v_pk_fma_f32 v[212:213], v[92:93], v[20:21], v[212:213] op_sel:[0,0,0] op_sel_hi:[1,0,1]
    v_pk_fma_f32 v[214:215], v[94:95], v[20:21], v[214:215] op_sel:[0,0,0] op_sel_hi:[1,0,1]
    v_pk_mul_f32 v[120:121], v[184:185], v[184:185]
    v_pk_mul_f32 v[128:129], v[186:187], v[186:187]
    v_pk_mul_f32 v[136:137], v[188:189], v[188:189]
    v_pk_mul_f32 v[144:145], v[190:191], v[190:191]
    v_pk_fma_f32 v[120:121], v[120:121], v[24:25], v[24:25] op_sel:[0,1,0] op_sel_hi:[1,1,0]
    v_pk_fma_f32 v[128:129], v[128:129], v[24:25], v[24:25] op_sel:[0,1,0] op_sel_hi:[1,1,0]
    v_pk_fma_f32 v[136:137], v[136:137], v[24:25], v[24:25] op_sel:[0,1,0] op_sel_hi:[1,1,0]
    v_pk_fma_f32 v[144:145], v[144:145], v[24:25], v[24:25] op_sel:[0,1,0] op_sel_hi:[1,1,0]
    v_pk_mul_f32 v[120:121], v[120:121], v[184:185]
    v_pk_mul_f32 v[128:129], v[128:129], v[186:187]
    v_pk_mul_f32 v[136:137], v[136:137], v[188:189]
    v_pk_mul_f32 v[144:145], v[144:145], v[190:191]
    v_exp_f32 v120, v120
    v_exp_f32 v121, v121
    v_exp_f32 v128, v128
    v_exp_f32 v129, v129
    v_exp_f32 v136, v136
    v_exp_f32 v137, v137
    v_exp_f32 v144, v144
    v_exp_f32 v145, v145
    v_pk_mul_f32 v[122:123], v[184:185], v[200:201]
    v_pk_mul_f32 v[130:131], v[186:187], v[202:203]
    v_pk_mul_f32 v[138:139], v[188:189], v[204:205]
    v_pk_mul_f32 v[146:147], v[190:191], v[206:207]
    v_pk_add_f32 v[120:121], v[120:121], s[86:87]
    v_pk_add_f32 v[128:129], v[128:129], s[86:87]
    v_pk_add_f32 v[136:137], v[136:137], s[86:87]
    v_pk_add_f32 v[144:145], v[144:145], s[86:87]
    v_pk_mul_f32 v[122:123], v[122:123], v[22:23] op_sel:[0,1] op_sel_hi:[1,1]
    v_pk_mul_f32 v[130:131], v[130:131], v[22:23] op_sel:[0,1] op_sel_hi:[1,1]
    v_pk_mul_f32 v[138:139], v[138:139], v[22:23] op_sel:[0,1] op_sel_hi:[1,1]
    v_pk_mul_f32 v[146:147], v[146:147], v[22:23] op_sel:[0,1] op_sel_hi:[1,1]
    v_rcp_f32 v120, v120
    v_rcp_f32 v121, v121
    v_rcp_f32 v128, v128
    v_rcp_f32 v129, v129
    v_rcp_f32 v136, v136
    v_rcp_f32 v137, v137
    v_rcp_f32 v144, v144
    v_rcp_f32 v145, v145
    v_pk_mul_f32 v[122:123], v[122:123], v[120:121]
    v_pk_mul_f32 v[130:131], v[130:131], v[128:129]
    v_pk_mul_f32 v[138:139], v[138:139], v[136:137]
    v_pk_mul_f32 v[146:147], v[146:147], v[144:145]
    v_cvt_pk_bf16_f32 v104, v122, v123
    v_cvt_pk_bf16_f32 v105, v130, v131
    v_cvt_pk_bf16_f32 v106, v138, v139
    v_cvt_pk_bf16_f32 v107, v146, v147
    v_pk_mul_f32 v[120:121], v[192:193], v[192:193]
    v_pk_mul_f32 v[128:129], v[194:195], v[194:195]
    v_pk_mul_f32 v[136:137], v[196:197], v[196:197]
    v_pk_mul_f32 v[144:145], v[198:199], v[198:199]
    v_pk_fma_f32 v[120:121], v[120:121], v[24:25], v[24:25] op_sel:[0,1,0] op_sel_hi:[1,1,0]
    v_pk_fma_f32 v[128:129], v[128:129], v[24:25], v[24:25] op_sel:[0,1,0] op_sel_hi:[1,1,0]
    v_pk_fma_f32 v[136:137], v[136:137], v[24:25], v[24:25] op_sel:[0,1,0] op_sel_hi:[1,1,0]
    v_pk_fma_f32 v[144:145], v[144:145], v[24:25], v[24:25] op_sel:[0,1,0] op_sel_hi:[1,1,0]
    v_pk_mul_f32 v[120:121], v[120:121], v[192:193]
    v_pk_mul_f32 v[128:129], v[128:129], v[194:195]
    v_pk_mul_f32 v[136:137], v[136:137], v[196:197]
    v_pk_mul_f32 v[144:145], v[144:145], v[198:199]
    v_exp_f32 v120, v120
    v_exp_f32 v121, v121
    v_exp_f32 v128, v128
    v_exp_f32 v129, v129
    v_exp_f32 v136, v136
    v_exp_f32 v137, v137
    v_exp_f32 v144, v144
    v_exp_f32 v145, v145
    v_pk_mul_f32 v[122:123], v[192:193], v[208:209]
    v_pk_mul_f32 v[130:131], v[194:195], v[210:211]
    v_pk_mul_f32 v[138:139], v[196:197], v[212:213]
    v_pk_mul_f32 v[146:147], v[198:199], v[214:215]
    v_pk_add_f32 v[120:121], v[120:121], s[86:87]
    v_pk_add_f32 v[128:129], v[128:129], s[86:87]
    v_pk_add_f32 v[136:137], v[136:137], s[86:87]
    v_pk_add_f32 v[144:145], v[144:145], s[86:87]
    v_pk_mul_f32 v[122:123], v[122:123], v[22:23] op_sel:[0,1] op_sel_hi:[1,1]
    v_pk_mul_f32 v[130:131], v[130:131], v[22:23] op_sel:[0,1] op_sel_hi:[1,1]
    v_pk_mul_f32 v[138:139], v[138:139], v[22:23] op_sel:[0,1] op_sel_hi:[1,1]
    v_pk_mul_f32 v[146:147], v[146:147], v[22:23] op_sel:[0,1] op_sel_hi:[1,1]
    v_rcp_f32 v120, v120
    v_rcp_f32 v121, v121
    v_rcp_f32 v128, v128
    v_rcp_f32 v129, v129
    v_rcp_f32 v136, v136
    v_rcp_f32 v137, v137
    v_rcp_f32 v144, v144
    v_rcp_f32 v145, v145
    v_pk_mul_f32 v[122:123], v[122:123], v[120:121]
    v_pk_mul_f32 v[130:131], v[130:131], v[128:129]
    v_pk_mul_f32 v[138:139], v[138:139], v[136:137]
    v_pk_mul_f32 v[146:147], v[146:147], v[144:145]
    v_cvt_pk_bf16_f32 v108, v122, v123
    v_cvt_pk_bf16_f32 v109, v130, v131
    v_cvt_pk_bf16_f32 v110, v138, v139
    v_cvt_pk_bf16_f32 v111, v146, v147
    s_nop 7
    s_cmp_eq_u32 s99, 0
    s_cbranch_scc1 L_slow_61
    buffer_store_dwordx4 v[104:107], v30, s[8:11], s54 offen offset:1024
    buffer_store_dwordx4 v[108:111], v30, s[8:11], s54 offen offset:1536
    s_branch L_join_62
L_slow_61:
    buffer_store_dwordx4 v[104:107], v30, s[8:11], s54 offen offset:1024 sc1
    buffer_store_dwordx4 v[108:111], v30, s[8:11], s54 offen offset:1536 sc1
L_join_62:
    s_nop 1
    s_cmp_lt_u32 s81, 3
    s_cbranch_scc1 L_nof2_58
    ds_read_b128 v[32:35], v31 offset:512
    ds_read_b128 v[36:39], v31 offset:528
    ds_read_b128 v[40:43], v31 offset:544
    ds_read_b128 v[44:47], v31 offset:560
    ds_read_b128 v[48:51], v31 offset:640
    ds_read_b128 v[52:55], v31 offset:656
    ds_read_b128 v[56:59], v31 offset:672
    ds_read_b128 v[60:63], v31 offset:688
    s_waitcnt lgkmcnt(0)
    v_pk_fma_f32 v[216:217], v[32:33], v[20:21], v[216:217] op_sel:[0,0,0] op_sel_hi:[1,0,1]
    v_pk_fma_f32 v[218:219], v[34:35], v[20:21], v[218:219] op_sel:[0,0,0] op_sel_hi:[1,0,1]
    v_pk_fma_f32 v[220:221], v[36:37], v[20:21], v[220:221] op_sel:[0,0,0] op_sel_hi:[1,0,1]
    v_pk_fma_f32 v[222:223], v[38:39], v[20:21], v[222:223] op_sel:[0,0,0] op_sel_hi:[1,0,1]
    v_pk_fma_f32 v[224:225], v[40:41], v[20:21], v[224:225] op_sel:[0,0,0] op_sel_hi:[1,0,1]
    v_pk_fma_f32 v[226:227], v[42:43], v[20:21], v[226:227] op_sel:[0,0,0] op_sel_hi:[1,0,1]
    v_pk_fma_f32 v[228:229], v[44:45], v[20:21], v[228:229] op_sel:[0,0,0] op_sel_hi:[1,0,1]
    v_pk_fma_f32 v[230:231], v[46:47], v[20:21], v[230:231] op_sel:[0,0,0] op_sel_hi:[1,0,1]
    v_pk_fma_f32 v[232:233], v[48:49], v[20:21], v[232:233] op_sel:[0,0,0] op_sel_hi:[1,0,1]
    v_pk_fma_f32 v[234:235], v[50:51], v[20:21], v[234:235] op_sel:[0,0,0] op_sel_hi:[1,0,1]
    v_pk_fma_f32 v[236:237], v[52:53], v[20:21], v[236:237] op_sel:[0,0,0] op_sel_hi:[1,0,1]
    v_pk_fma_f32 v[238:239], v[54:55], v[20:21], v[238:239] op_sel:[0,0,0] op_sel_hi:[1,0,1]
    v_pk_fma_f32 v[240:241], v[56:57], v[20:21], v[240:241] op_sel:[0,0,0] op_sel_hi:[1,0,1]
    v_pk_fma_f32 v[242:243], v[58:59], v[20:21], v[242:243] op_sel:[0,0,0] op_sel_hi:[1,0,1]
    v_pk_fma_f32 v[244:245], v[60:61], v[20:21], v[244:245] op_sel:[0,0,0] op_sel_hi:[1,0,1]
    v_pk_fma_f32 v[246:247], v[62:63], v[20:21], v[246:247] op_sel:[0,0,0] op_sel_hi:[1,0,1]
    v_pk_mul_f32 v[120:121], v[216:217], v[216:217]
    v_pk_mul_f32 v[128:129], v[218:219], v[218:219]
    v_pk_mul_f32 v[136:137], v[220:221], v[220:221]
    v_pk_mul_f32 v[144:145], v[222:223], v[222:223]
    v_pk_fma_f32 v[120:121], v[120:121], v[24:25], v[24:25] op_sel:[0,1,0] op_sel_hi:[1,1,0]
    v_pk_fma_f32 v[128:129], v[128:129], v[24:25], v[24:25] op_sel:[0,1,0] op_sel_hi:[1,1,0]
    v_pk_fma_f32 v[136:137], v[136:137], v[24:25], v[24:25] op_sel:[0,1,0] op_sel_hi:[1,1,0]
    v_pk_fma_f32 v[144:145], v[144:145], v[24:25], v[24:25] op_sel:[0,1,0] op_sel_hi:[1,1,0]
    v_pk_mul_f32 v[120:121], v[120:121], v[216:217]
    v_pk_mul_f32 v[128:129], v[128:129], v[218:219]
    v_pk_mul_f32 v[136:137], v[136:137], v[220:221]
    v_pk_mul_f32 v[144:145], v[144:145], v[222:223]
    v_exp_f32 v120, v120
    v_exp_f32 v121, v121
    v_exp_f32 v128, v128
    v_exp_f32 v129, v129
    v_exp_f32 v136, v136
    v_exp_f32 v137, v137
    v_exp_f32 v144, v144
    v_exp_f32 v145, v145
    v_pk_mul_f32 v[122:123], v[216:217], v[232:233]
    v_pk_mul_f32 v[130:131], v[218:219], v[234:235]
    v_pk_mul_f32 v[138:139], v[220:221], v[236:237]
    v_pk_mul_f32 v[146:147], v[222:223], v[238:239]
    v_pk_add_f32 v[120:121], v[120:121], s[86:87]
    v_pk_add_f32 v[128:129], v[128:129], s[86:87]
    v_pk_add_f32 v[136:137], v[136:137], s[86:87]
    v_pk_add_f32 v[144:145], v[144:145], s[86:87]
    v_pk_mul_f32 v[122:123], v[122:123], v[22:23] op_sel:[0,1] op_sel_hi:[1,1]
    v_pk_mul_f32 v[130:131], v[130:131], v[22:23] op_sel:[0,1] op_sel_hi:[1,1]
    v_pk_mul_f32 v[138:139], v[138:139], v[22:23] op_sel:[0,1] op_sel_hi:[1,1]
    v_pk_mul_f32 v[146:147], v[146:147], v[22:23] op_sel:[0,1] op_sel_hi:[1,1]
    v_rcp_f32 v120, v120
    v_rcp_f32 v121, v121
    v_rcp_f32 v128, v128
    v_rcp_f32 v129, v129
    v_rcp_f32 v136, v136
    v_rcp_f32 v137, v137
    v_rcp_f32 v144, v144
    v_rcp_f32 v145, v145
    v_pk_mul_f32 v[122:123], v[122:123], v[120:121]
    v_pk_mul_f32 v[130:131], v[130:131], v[128:129]
    v_pk_mul_f32 v[138:139], v[138:139], v[136:137]
    v_pk_mul_f32 v[146:147], v[146:147], v[144:145]
    v_cvt_pk_bf16_f32 v112, v122, v123
    v_cvt_pk_bf16_f32 v113, v130, v131
    v_cvt_pk_bf16_f32 v114, v138, v139
    v_cvt_pk_bf16_f32 v115, v146, v147
    v_pk_mul_f32 v[120:121], v[224:225], v[224:225]
    v_pk_mul_f32 v[128:129], v[226:227], v[226:227]
    v_pk_mul_f32 v[136:137], v[228:229], v[228:229]
    v_pk_mul_f32 v[144:145], v[230:231], v[230:231]
    v_pk_fma_f32 v[120:121], v[120:121], v[24:25], v[24:25] op_sel:[0,1,0] op_sel_hi:[1,1,0]
    v_pk_fma_f32 v[128:129], v[128:129], v[24:25], v[24:25] op_sel:[0,1,0] op_sel_hi:[1,1,0]
    v_pk_fma_f32 v[136:137], v[136:137], v[24:25], v[24:25] op_sel:[0,1,0] op_sel_hi:[1,1,0]
    v_pk_fma_f32 v[144:145], v[144:145], v[24:25], v[24:25] op_sel:[0,1,0] op_sel_hi:[1,1,0]
    v_pk_mul_f32 v[120:121], v[120:121], v[224:225]
    v_pk_mul_f32 v[128:129], v[128:129], v[226:227]
    v_pk_mul_f32 v[136:137], v[136:137], v[228:229]
    v_pk_mul_f32 v[144:145], v[144:145], v[230:231]
    v_exp_f32 v120, v120
    v_exp_f32 v121, v121
    v_exp_f32 v128, v128
    v_exp_f32 v129, v129
    v_exp_f32 v136, v136
    v_exp_f32 v137, v137
    v_exp_f32 v144, v144
    v_exp_f32 v145, v145
    v_pk_mul_f32 v[122:123], v[224:225], v[240:241]
    v_pk_mul_f32 v[130:131], v[226:227], v[242:243]
    v_pk_mul_f32 v[138:139], v[228:229], v[244:245]
    v_pk_mul_f32 v[146:147], v[230:231], v[246:247]
    v_pk_add_f32 v[120:121], v[120:121], s[86:87]
    v_pk_add_f32 v[128:129], v[128:129], s[86:87]
    v_pk_add_f32 v[136:137], v[136:137], s[86:87]
    v_pk_add_f32 v[144:145], v[144:145], s[86:87]
    v_pk_mul_f32 v[122:123], v[122:123], v[22:23] op_sel:[0,1] op_sel_hi:[1,1]
    v_pk_mul_f32 v[130:131], v[130:131], v[22:23] op_sel:[0,1] op_sel_hi:[1,1]
    v_pk_mul_f32 v[138:139], v[138:139], v[22:23] op_sel:[0,1] op_sel_hi:[1,1]
    v_pk_mul_f32 v[146:147], v[146:147], v[22:23] op_sel:[0,1] op_sel_hi:[1,1]
    v_rcp_f32 v120, v120
    v_rcp_f32 v121, v121
    v_rcp_f32 v128, v128
    v_rcp_f32 v129, v129
    v_rcp_f32 v136, v136
    v_rcp_f32 v137, v137
    v_rcp_f32 v144, v144
    v_rcp_f32 v145, v145
    v_pk_mul_f32 v[122:123], v[122:123], v[120:121]
    v_pk_mul_f32 v[130:131], v[130:131], v[128:129]
    v_pk_mul_f32 v[138:139], v[138:139], v[136:137]
    v_pk_mul_f32 v[146:147], v[146:147], v[144:145]
    v_cvt_pk_bf16_f32 v116, v122, v123
    v_cvt_pk_bf16_f32 v117, v130, v131
    v_cvt_pk_bf16_f32 v118, v138, v139
    v_cvt_pk_bf16_f32 v119, v146, v147
    s_nop 7
    s_cmp_eq_u32 s99, 0
    s_cbranch_scc1 L_slow_63
    buffer_store_dwordx4 v[112:115], v30, s[8:11], s54 offen offset:2048
    buffer_store_dwordx4 v[116:119], v30, s[8:11], s54 offen offset:2560
    s_branch L_join_64
L_slow_63:
    buffer_store_dwordx4 v[112:115], v30, s[8:11], s54 offen offset:2048 sc1
    buffer_store_dwordx4 v[116:119], v30, s[8:11], s54 offen offset:2560 sc1
L_join_64:
    s_nop 1
L_nof2_58:
    s_nop 1
    v_mov_b32 v16, v1
    v_add_u32 v17, 0x10000, v1
    v_add_u32 v18, 0x20000, v1
    v_mov_b32 v32, 0
    v_mov_b32 v33, 0
    v_mov_b32 v34, 0
    v_mov_b32 v35, 0
    v_mov_b32 v36, 0
    v_mov_b32 v37, 0
    v_mov_b32 v38, 0
    v_mov_b32 v39, 0
    v_mov_b32 v40, 0
    v_mov_b32 v41, 0
    v_mov_b32 v42, 0
    v_mov_b32 v43, 0
    v_mov_b32 v44, 0
    v_mov_b32 v45, 0
    v_mov_b32 v46, 0
    v_mov_b32 v47, 0
    s_mul_i32 s58, s63, 44032
    s_add_u32 s58, s58, s50
    s_add_u32 s58, s58, 12582912
    v_and_b32 v251, 15, v15
    s_lshr_b32 s54, s44, 1
    s_lshl_b32 s54, s54, 4
    v_add_u32 v251, s54, v251
    v_lshlrev_b32 v251, 2, v251
    s_waitcnt vmcnt(0)
    s_barrier
    s_cmp_lg_u32 s46, 0
    s_cbranch_scc1 L_w0skip_65
    s_lshl_b32 s54, s44, 3
    s_add_u32 s54, s54, s45
    s_lshl_b32 s54, s54, 2
    s_add_u32 s54, s54, s52
    s_add_u32 s54, s54, 26217472
    s_mov_b64 s[92:93], exec
    s_mov_b64 exec, 1
    v_mov_b32 v252, 0
    v_mov_b32 v253, s47
    s_cmp_eq_u32 s99, 0
    s_cbranch_scc1 L_fslow_66
    buffer_store_dword v253, v252, s[8:11], s54 offen
    s_branch L_fjoin_67
L_fslow_66:
    buffer_store_dword v253, v252, s[8:11], s54 offen sc1
L_fjoin_67:
    s_mov_b64 exec, s[92:93]
    s_add_u32 s54, s52, 26217472
    s_mov_b32 s83, 0
L_poll_68:
    buffer_load_dword v253, v251, s[8:11], s54 offen sc1
    s_waitcnt vmcnt(0)
    s_waitcnt vmcnt(0)
    v_and_b32 v252, -16, v253
    v_cmp_ne_u32 vcc, s47, v252
    s_nop 3
    s_cmp_eq_u64 vcc, 0
    s_cbranch_scc1 L_pdone_69
    s_add_u32 s83, s83, 1
    s_cmp_lt_u32 s83, 200000
    s_cbranch_scc1 L_poll_68
L_pdone_69:
L_w0skip_65:
    s_nop 3
    s_barrier
    s_add_u32 s54, s58, 0
    buffer_load_dwordx4 v[96:99], v1, s[8:11], s54 offen sc1
    buffer_load_dwordx4 v[100:103], v1, s[8:11], s54 offen offset:1024 sc1
    buffer_load_dwordx4 v[104:107], v1, s[8:11], s54 offen offset:2048 sc1
    buffer_load_dwordx4 v[108:111], v1, s[8:11], s54 offen offset:3072 sc1
    s_add_u32 s54, s58, 4096
    buffer_load_dwordx4 v[112:115], v1, s[8:11], s54 offen sc1
    buffer_load_dwordx4 v[116:119], v1, s[8:11], s54 offen offset:1024 sc1
    buffer_load_dwordx4 v[120:123], v1, s[8:11], s54 offen offset:2048 sc1
    buffer_load_dwordx4 v[124:127], v1, s[8:11], s54 offen offset:3072 sc1
    s_add_u32 s54, s58, 8192
    buffer_load_dwordx4 v[128:131], v1, s[8:11], s54 offen sc1
    buffer_load_dwordx4 v[132:135], v1, s[8:11], s54 offen offset:1024 sc1
    ds_read_b128 v[48:51], v18 offset:16384
    ds_read_b128 v[52:55], v18 offset:17408
    ds_read_b128 v[56:59], v18 offset:18432
    ds_read_b128 v[60:63], v18 offset:19456
    ds_read_b128 v[64:67], v18 offset:20480
    ds_read_b128 v[68:71], v18 offset:21504
    s_waitcnt vmcnt(9)
    s_waitcnt lgkmcnt(4)
    v_mfma_f32_16x16x32_bf16 v[32:35], v[48:51], v[96:99], v[32:35]
    ds_read_b128 v[72:75], v18 offset:22528
    v_mfma_f32_16x16x32_bf16 v[36:39], v[52:55], v[96:99], v[36:39]
    ds_read_b128 v[76:79], v18 offset:23552
    buffer_load_dwordx4 v[136:139], v1, s[8:11], s54 offen offset:2048 sc1
    s_waitcnt lgkmcnt(4)
    v_mfma_f32_16x16x32_bf16 v[40:43], v[56:59], v[96:99], v[40:43]
    ds_read_b128 v[48:51], v17 offset:57344
    v_mfma_f32_16x16x32_bf16 v[44:47], v[60:63], v[96:99], v[44:47]
    ds_read_b128 v[52:55], v17 offset:58368
    buffer_load_dwordx4 v[140:143], v1, s[8:11], s54 offen offset:3072 sc1
    s_waitcnt vmcnt(10)
    s_waitcnt lgkmcnt(4)
    v_mfma_f32_16x16x32_bf16 v[32:35], v[64:67], v[100:103], v[32:35]
    ds_read_b128 v[56:59], v17 offset:59392
    v_mfma_f32_16x16x32_bf16 v[36:39], v[68:71], v[100:103], v[36:39]
    ds_read_b128 v[60:63], v17 offset:60416
    s_add_u32 s54, s58, 12288
    buffer_load_dwordx4 v[144:147], v1, s[8:11], s54 offen sc1
    s_waitcnt lgkmcnt(4)
    v_mfma_f32_16x16x32_bf16 v[40:43], v[72:75], v[100:103], v[40:43]
    ds_read_b128 v[64:67], v17 offset:61440
    v_mfma_f32_16x16x32_bf16 v[44:47], v[76:79], v[100:103], v[44:47]
    ds_read_b128 v[68:71], v17 offset:62464
    s_waitcnt vmcnt(10)
    s_waitcnt lgkmcnt(4)
    v_mfma_f32_16x16x32_bf16 v[32:35], v[48:51], v[104:107], v[32:35]
    ds_read_b128 v[72:75], v17 offset:63488
    v_mfma_f32_16x16x32_bf16 v[36:39], v[52:55], v[104:107], v[36:39]
    ds_read_b128 v[76:79], v17 offset:64512
    buffer_load_dwordx4 v[148:151], v1, s[8:11], s54 offen offset:1024 sc1
    s_waitcnt lgkmcnt(4)
    v_mfma_f32_16x16x32_bf16 v[40:43], v[56:59], v[104:107], v[40:43]
    ds_read_b128 v[48:51], v18 offset:0
    v_mfma_f32_16x16x32_bf16 v[44:47], v[60:63], v[104:107], v[44:47]
    ds_read_b128 v[52:55], v18 offset:1024
    s_waitcnt vmcnt(10)
    s_waitcnt lgkmcnt(4)
    v_mfma_f32_16x16x32_bf16 v[32:35], v[64:67], v[108:111], v[32:35]
    ds_read_b128 v[56:59], v18 offset:2048
    v_mfma_f32_16x16x32_bf16 v[36:39], v[68:71], v[108:111], v[36:39]
    ds_read_b128 v[60:63], v18 offset:3072
    buffer_load_dwordx4 v[152:155], v1, s[8:11], s54 offen offset:2048 sc1
    s_waitcnt lgkmcnt(4)
    v_mfma_f32_16x16x32_bf16 v[40:43], v[72:75], v[108:111], v[40:43]
    ds_read_b128 v[64:67], v18 offset:4096
    v_mfma_f32_16x16x32_bf16 v[44:47], v[76:79], v[108:111], v[44:47]
    ds_read_b128 v[68:71], v18 offset:5120
    s_waitcnt vmcnt(10)
    s_waitcnt lgkmcnt(4)
    v_mfma_f32_16x16x32_bf16 v[32:35], v[48:51], v[112:115], v[32:35]
    ds_read_b128 v[72:75], v18 offset:6144
    v_mfma_f32_16x16x32_bf16 v[36:39], v[52:55], v[112:115], v[36:39]
    ds_read_b128 v[76:79], v18 offset:7168
    buffer_load_dwordx4 v[156:159], v1, s[8:11], s54 offen offset:3072 sc1
    s_waitcnt lgkmcnt(4)
    v_mfma_f32_16x16x32_bf16 v[40:43], v[56:59], v[112:115], v[40:43]
    ds_read_b128 v[48:51], v18 offset:8192
    v_mfma_f32_16x16x32_bf16 v[44:47], v[60:63], v[112:115], v[44:47]
    ds_read_b128 v[52:55], v18 offset:9216
    s_waitcnt vmcnt(10)
    s_waitcnt lgkmcnt(4)
    v_mfma_f32_16x16x32_bf16 v[32:35], v[64:67], v[116:119], v[32:35]
    ds_read_b128 v[56:59], v18 offset:10240
    v_mfma_f32_16x16x32_bf16 v[36:39], v[68:71], v[116:119], v[36:39]
    ds_read_b128 v[60:63], v18 offset:11264
    s_add_u32 s54, s58, 16384
    buffer_load_dwordx4 v[160:163], v1, s[8:11], s54 offen sc1
    s_waitcnt lgkmcnt(4)
    v_mfma_f32_16x16x32_bf16 v[40:43], v[72:75], v[116:119], v[40:43]
    ds_read_b128 v[64:67], v18 offset:12288
    v_mfma_f32_16x16x32_bf16 v[44:47], v[76:79], v[116:119], v[44:47]
    ds_read_b128 v[68:71], v18 offset:13312
    s_waitcnt vmcnt(10)
    s_waitcnt lgkmcnt(4)
    v_mfma_f32_16x16x32_bf16 v[32:35], v[48:51], v[120:123], v[32:35]
    ds_read_b128 v[72:75], v18 offset:14336
    v_mfma_f32_16x16x32_bf16 v[36:39], v[52:55], v[120:123], v[36:39]
    ds_read_b128 v[76:79], v18 offset:15360
    buffer_load_dwordx4 v[164:167], v1, s[8:11], s54 offen offset:1024 sc1
    s_barrier
    s_waitcnt lgkmcnt(4)
    v_mfma_f32_16x16x32_bf16 v[40:43], v[56:59], v[120:123], v[40:43]
    ds_read_b128 v[48:51], v16 offset:0
    v_mfma_f32_16x16x32_bf16 v[44:47], v[60:63], v[120:123], v[44:47]
    ds_read_b128 v[52:55], v16 offset:1024
    s_waitcnt vmcnt(10)
    s_waitcnt lgkmcnt(4)
    v_mfma_f32_16x16x32_bf16 v[32:35], v[64:67], v[124:127], v[32:35]
    ds_read_b128 v[56:59], v16 offset:2048
    v_mfma_f32_16x16x32_bf16 v[36:39], v[68:71], v[124:127], v[36:39]
    ds_read_b128 v[60:63], v16 offset:3072
    buffer_load_dwordx4 v[168:171], v1, s[8:11], s54 offen offset:2048 sc1
    s_waitcnt lgkmcnt(4)
    v_mfma_f32_16x16x32_bf16 v[40:43], v[72:75], v[124:127], v[40:43]
    ds_read_b128 v[64:67], v16 offset:4096
    v_mfma_f32_16x16x32_bf16 v[44:47], v[76:79], v[124:127], v[44:47]
    ds_read_b128 v[68:71], v16 offset:5120
    s_waitcnt vmcnt(10)
    s_waitcnt lgkmcnt(4)
    v_mfma_f32_16x16x32_bf16 v[32:35], v[48:51], v[128:131], v[32:35]
    ds_read_b128 v[72:75], v16 offset:6144
    v_mfma_f32_16x16x32_bf16 v[36:39], v[52:55], v[128:131], v[36:39]
    ds_read_b128 v[76:79], v16 offset:7168
    buffer_load_dwordx4 v[172:175], v1, s[8:11], s54 offen offset:3072 sc1
    s_waitcnt lgkmcnt(4)
    v_mfma_f32_16x16x32_bf16 v[40:43], v[56:59], v[128:131], v[40:43]
    ds_read_b128 v[48:51], v16 offset:8192
    v_mfma_f32_16x16x32_bf16 v[44:47], v[60:63], v[128:131], v[44:47]
    ds_read_b128 v[52:55], v16 offset:9216
    s_waitcnt vmcnt(10)
    s_waitcnt lgkmcnt(4)
    v_mfma_f32_16x16x32_bf16 v[32:35], v[64:67], v[132:135], v[32:35]
    ds_read_b128 v[56:59], v16 offset:10240
    v_mfma_f32_16x16x32_bf16 v[36:39], v[68:71], v[132:135], v[36:39]
    ds_read_b128 v[60:63], v16 offset:11264
    s_add_u32 s54, s58, 20480
    buffer_load_dwordx4 v[176:179], v1, s[8:11], s54 offen sc1
    s_waitcnt lgkmcnt(4)
    v_mfma_f32_16x16x32_bf16 v[40:43], v[72:75], v[132:135], v[40:43]
    ds_read_b128 v[64:67], v16 offset:12288
    v_mfma_f32_16x16x32_bf16 v[44:47], v[76:79], v[132:135], v[44:47]
    ds_read_b128 v[68:71], v16 offset:13312
    s_waitcnt vmcnt(10)
    s_waitcnt lgkmcnt(4)
    v_mfma_f32_16x16x32_bf16 v[32:35], v[48:51], v[136:139], v[32:35]
    ds_read_b128 v[72:75], v16 offset:14336
    v_mfma_f32_16x16x32_bf16 v[36:39], v[52:55], v[136:139], v[36:39]
    ds_read_b128 v[76:79], v16 offset:15360
    buffer_load_dwordx4 v[180:183], v1, s[8:11], s54 offen offset:1024 sc1
    s_waitcnt lgkmcnt(4)
    v_mfma_f32_16x16x32_bf16 v[40:43], v[56:59], v[136:139], v[40:43]
    ds_read_b128 v[48:51], v16 offset:16384
    v_mfma_f32_16x16x32_bf16 v[44:47], v[60:63], v[136:139], v[44:47]
    ds_read_b128 v[52:55], v16 offset:17408
    s_waitcnt vmcnt(10)
    s_waitcnt lgkmcnt(4)
    v_mfma_f32_16x16x32_bf16 v[32:35], v[64:67], v[140:143], v[32:35]
    ds_read_b128 v[56:59], v16 offset:18432
    v_mfma_f32_16x16x32_bf16 v[36:39], v[68:71], v[140:143], v[36:39]
    ds_read_b128 v[60:63], v16 offset:19456
    buffer_load_dwordx4 v[184:187], v1, s[8:11], s54 offen offset:2048 sc1
    s_waitcnt lgkmcnt(4)
    v_mfma_f32_16x16x32_bf16 v[40:43], v[72:75], v[140:143], v[40:43]
    ds_read_b128 v[64:67], v16 offset:20480
    v_mfma_f32_16x16x32_bf16 v[44:47], v[76:79], v[140:143], v[44:47]
    ds_read_b128 v[68:71], v16 offset:21504
    s_waitcnt vmcnt(10)
    s_waitcnt lgkmcnt(4)
    v_mfma_f32_16x16x32_bf16 v[32:35], v[48:51], v[144:147], v[32:35]
    ds_read_b128 v[72:75], v16 offset:22528
    v_mfma_f32_16x16x32_bf16 v[36:39], v[52:55], v[144:147], v[36:39]
    ds_read_b128 v[76:79], v16 offset:23552
    buffer_load_dwordx4 v[188:191], v1, s[8:11], s54 offen offset:3072 sc1
    s_waitcnt lgkmcnt(4)
    v_mfma_f32_16x16x32_bf16 v[40:43], v[56:59], v[144:147], v[40:43]
    ds_read_b128 v[48:51], v16 offset:24576
    v_mfma_f32_16x16x32_bf16 v[44:47], v[60:63], v[144:147], v[44:47]
    ds_read_b128 v[52:55], v16 offset:25600
    s_waitcnt vmcnt(10)
    s_waitcnt lgkmcnt(4)
    v_mfma_f32_16x16x32_bf16 v[32:35], v[64:67], v[148:151], v[32:35]
    ds_read_b128 v[56:59], v16 offset:26624
    v_mfma_f32_16x16x32_bf16 v[36:39], v[68:71], v[148:151], v[36:39]
    ds_read_b128 v[60:63], v16 offset:27648
    s_add_u32 s54, s58, 24576
    buffer_load_dwordx4 v[192:195], v1, s[8:11], s54 offen sc1
    s_waitcnt lgkmcnt(4)
    v_mfma_f32_16x16x32_bf16 v[40:43], v[72:75], v[148:151], v[40:43]
    ds_read_b128 v[64:67], v16 offset:28672
    v_mfma_f32_16x16x32_bf16 v[44:47], v[76:79], v[148:151], v[44:47]
    ds_read_b128 v[68:71], v16 offset:29696
    s_waitcnt vmcnt(10)
    s_waitcnt lgkmcnt(4)
    v_mfma_f32_16x16x32_bf16 v[32:35], v[48:51], v[152:155], v[32:35]
    ds_read_b128 v[72:75], v16 offset:30720
    v_mfma_f32_16x16x32_bf16 v[36:39], v[52:55], v[152:155], v[36:39]
    ds_read_b128 v[76:79], v16 offset:31744
    buffer_load_dwordx4 v[196:199], v1, s[8:11], s54 offen offset:1024 sc1
    s_waitcnt lgkmcnt(4)
    v_mfma_f32_16x16x32_bf16 v[40:43], v[56:59], v[152:155], v[40:43]
    ds_read_b128 v[48:51], v16 offset:32768
    v_mfma_f32_16x16x32_bf16 v[44:47], v[60:63], v[152:155], v[44:47]
    ds_read_b128 v[52:55], v16 offset:33792
    s_waitcnt vmcnt(10)
    s_waitcnt lgkmcnt(4)
    v_mfma_f32_16x16x32_bf16 v[32:35], v[64:67], v[156:159], v[32:35]
    ds_read_b128 v[56:59], v16 offset:34816
    v_mfma_f32_16x16x32_bf16 v[36:39], v[68:71], v[156:159], v[36:39]
    ds_read_b128 v[60:63], v16 offset:35840
    buffer_load_dwordx4 v[200:203], v1, s[8:11], s54 offen offset:2048 sc1
    s_waitcnt lgkmcnt(4)
    v_mfma_f32_16x16x32_bf16 v[40:43], v[72:75], v[156:159], v[40:43]
    ds_read_b128 v[64:67], v16 offset:36864
    v_mfma_f32_16x16x32_bf16 v[44:47], v[76:79], v[156:159], v[44:47]
    ds_read_b128 v[68:71], v16 offset:37888
    s_waitcnt vmcnt(10)
    s_waitcnt lgkmcnt(4)
    v_mfma_f32_16x16x32_bf16 v[32:35], v[48:51], v[160:163], v[32:35]
    ds_read_b128 v[72:75], v16 offset:38912
    v_mfma_f32_16x16x32_bf16 v[36:39], v[52:55], v[160:163], v[36:39]
    ds_read_b128 v[76:79], v16 offset:39936
    buffer_load_dwordx4 v[204:207], v1, s[8:11], s54 offen offset:3072 sc1
    s_waitcnt lgkmcnt(4)
    v_mfma_f32_16x16x32_bf16 v[40:43], v[56:59], v[160:163], v[40:43]
    ds_read_b128 v[48:51], v16 offset:40960
    v_mfma_f32_16x16x32_bf16 v[44:47], v[60:63], v[160:163], v[44:47]
    ds_read_b128 v[52:55], v16 offset:41984
    s_waitcnt vmcnt(10)
    s_waitcnt lgkmcnt(4)
    v_mfma_f32_16x16x32_bf16 v[32:35], v[64:67], v[164:167], v[32:35]
    ds_read_b128 v[56:59], v16 offset:43008
    v_mfma_f32_16x16x32_bf16 v[36:39], v[68:71], v[164:167], v[36:39]
    ds_read_b128 v[60:63], v16 offset:44032
    s_add_u32 s54, s58, 28672
    buffer_load_dwordx4 v[208:211], v1, s[8:11], s54 offen sc1
    s_waitcnt lgkmcnt(4)
    v_mfma_f32_16x16x32_bf16 v[40:43], v[72:75], v[164:167], v[40:43]
    ds_read_b128 v[64:67], v16 offset:45056
    v_mfma_f32_16x16x32_bf16 v[44:47], v[76:79], v[164:167], v[44:47]
    ds_read_b128 v[68:71], v16 offset:46080
    s_waitcnt vmcnt(10)
    s_waitcnt lgkmcnt(4)
    v_mfma_f32_16x16x32_bf16 v[32:35], v[48:51], v[168:171], v[32:35]
    ds_read_b128 v[72:75], v16 offset:47104
    v_mfma_f32_16x16x32_bf16 v[36:39], v[52:55], v[168:171], v[36:39]
    ds_read_b128 v[76:79], v16 offset:48128
    buffer_load_dwordx4 v[212:215], v1, s[8:11], s54 offen offset:1024 sc1
    s_waitcnt lgkmcnt(4)
    v_mfma_f32_16x16x32_bf16 v[40:43], v[56:59], v[168:171], v[40:43]
    ds_read_b128 v[48:51], v16 offset:49152
    v_mfma_f32_16x16x32_bf16 v[44:47], v[60:63], v[168:171], v[44:47]
    ds_read_b128 v[52:55], v16 offset:50176
    s_waitcnt vmcnt(10)
    s_waitcnt lgkmcnt(4)
    v_mfma_f32_16x16x32_bf16 v[32:35], v[64:67], v[172:175], v[32:35]
    ds_read_b128 v[56:59], v16 offset:51200
    v_mfma_f32_16x16x32_bf16 v[36:39], v[68:71], v[172:175], v[36:39]
    ds_read_b128 v[60:63], v16 offset:52224
    buffer_load_dwordx4 v[216:219], v1, s[8:11], s54 offen offset:2048 sc1
    s_waitcnt lgkmcnt(4)
    v_mfma_f32_16x16x32_bf16 v[40:43], v[72:75], v[172:175], v[40:43]
    ds_read_b128 v[64:67], v16 offset:53248
    v_mfma_f32_16x16x32_bf16 v[44:47], v[76:79], v[172:175], v[44:47]
    ds_read_b128 v[68:71], v16 offset:54272
    s_waitcnt vmcnt(10)
    s_waitcnt lgkmcnt(4)
    v_mfma_f32_16x16x32_bf16 v[32:35], v[48:51], v[176:179], v[32:35]
    ds_read_b128 v[72:75], v16 offset:55296
    v_mfma_f32_16x16x32_bf16 v[36:39], v[52:55], v[176:179], v[36:39]
    ds_read_b128 v[76:79], v16 offset:56320
    buffer_load_dwordx4 v[220:223], v1, s[8:11], s54 offen offset:3072 sc1
    s_waitcnt lgkmcnt(4)
    v_mfma_f32_16x16x32_bf16 v[40:43], v[56:59], v[176:179], v[40:43]
    ds_read_b128 v[48:51], v16 offset:57344
    v_mfma_f32_16x16x32_bf16 v[44:47], v[60:63], v[176:179], v[44:47]
    ds_read_b128 v[52:55], v16 offset:58368
    s_waitcnt vmcnt(10)
    s_waitcnt lgkmcnt(4)
    v_mfma_f32_16x16x32_bf16 v[32:35], v[64:67], v[180:183], v[32:35]
    ds_read_b128 v[56:59], v16 offset:59392
    v_mfma_f32_16x16x32_bf16 v[36:39], v[68:71], v[180:183], v[36:39]
    ds_read_b128 v[60:63], v16 offset:60416
    s_add_u32 s54, s58, 32768
    buffer_load_dwordx4 v[96:99], v1, s[8:11], s54 offen sc1
    s_waitcnt lgkmcnt(4)
    v_mfma_f32_16x16x32_bf16 v[40:43], v[72:75], v[180:183], v[40:43]
    ds_read_b128 v[64:67], v16 offset:61440
    v_mfma_f32_16x16x32_bf16 v[44:47], v[76:79], v[180:183], v[44:47]
    ds_read_b128 v[68:71], v16 offset:62464
    s_waitcnt vmcnt(10)
    s_waitcnt lgkmcnt(4)
    v_mfma_f32_16x16x32_bf16 v[32:35], v[48:51], v[184:187], v[32:35]
    ds_read_b128 v[72:75], v16 offset:63488
    v_mfma_f32_16x16x32_bf16 v[36:39], v[52:55], v[184:187], v[36:39]
    ds_read_b128 v[76:79], v16 offset:64512
    buffer_load_dwordx4 v[100:103], v1, s[8:11], s54 offen offset:1024 sc1
    s_waitcnt lgkmcnt(4)
    v_mfma_f32_16x16x32_bf16 v[40:43], v[56:59], v[184:187], v[40:43]
    ds_read_b128 v[48:51], v17 offset:0
    v_mfma_f32_16x16x32_bf16 v[44:47], v[60:63], v[184:187], v[44:47]
    ds_read_b128 v[52:55], v17 offset:1024
    s_waitcnt vmcnt(10)
    s_waitcnt lgkmcnt(4)
    v_mfma_f32_16x16x32_bf16 v[32:35], v[64:67], v[188:191], v[32:35]
    ds_read_b128 v[56:59], v17 offset:2048
    v_mfma_f32_16x16x32_bf16 v[36:39], v[68:71], v[188:191], v[36:39]
    ds_read_b128 v[60:63], v17 offset:3072
    buffer_load_dwordx4 v[104:107], v1, s[8:11], s54 offen offset:2048 sc1
    s_waitcnt lgkmcnt(4)
    v_mfma_f32_16x16x32_bf16 v[40:43], v[72:75], v[188:191], v[40:43]
    ds_read_b128 v[64:67], v17 offset:4096
    v_mfma_f32_16x16x32_bf16 v[44:47], v[76:79], v[188:191], v[44:47]
    ds_read_b128 v[68:71], v17 offset:5120
    s_waitcnt vmcnt(10)
    s_waitcnt lgkmcnt(4)
    v_mfma_f32_16x16x32_bf16 v[32:35], v[48:51], v[192:195], v[32:35]
    ds_read_b128 v[72:75], v17 offset:6144
    v_mfma_f32_16x16x32_bf16 v[36:39], v[52:55], v[192:195], v[36:39]
    ds_read_b128 v[76:79], v17 offset:7168
    buffer_load_dwordx4 v[108:111], v1, s[8:11], s54 offen offset:3072 sc1
    s_waitcnt lgkmcnt(4)
    v_mfma_f32_16x16x32_bf16 v[40:43], v[56:59], v[192:195], v[40:43]
    ds_read_b128 v[48:51], v17 offset:8192
    v_mfma_f32_16x16x32_bf16 v[44:47], v[60:63], v[192:195], v[44:47]
    ds_read_b128 v[52:55], v17 offset:9216
    s_waitcnt vmcnt(10)
    s_waitcnt lgkmcnt(4)
    v_mfma_f32_16x16x32_bf16 v[32:35], v[64:67], v[196:199], v[32:35]
    ds_read_b128 v[56:59], v17 offset:10240
    v_mfma_f32_16x16x32_bf16 v[36:39], v[68:71], v[196:199], v[36:39]
    ds_read_b128 v[60:63], v17 offset:11264
    s_add_u32 s54, s58, 36864
    buffer_load_dwordx4 v[112:115], v1, s[8:11], s54 offen sc1
    s_waitcnt lgkmcnt(4)
    v_mfma_f32_16x16x32_bf16 v[40:43], v[72:75], v[196:199], v[40:43]
    ds_read_b128 v[64:67], v17 offset:12288
    v_mfma_f32_16x16x32_bf16 v[44:47], v[76:79], v[196:199], v[44:47]
    ds_read_b128 v[68:71], v17 offset:13312
    s_waitcnt vmcnt(10)
    s_waitcnt lgkmcnt(4)
    v_mfma_f32_16x16x32_bf16 v[32:35], v[48:51], v[200:203], v[32:35]
    ds_read_b128 v[72:75], v17 offset:14336
    v_mfma_f32_16x16x32_bf16 v[36:39], v[52:55], v[200:203], v[36:39]
    ds_read_b128 v[76:79], v17 offset:15360
    buffer_load_dwordx4 v[116:119], v1, s[8:11], s54 offen offset:1024 sc1
    s_barrier
    s_waitcnt lgkmcnt(4)
    v_mfma_f32_16x16x32_bf16 v[40:43], v[56:59], v[200:203], v[40:43]
    ds_read_b128 v[48:51], v17 offset:16384
    v_mfma_f32_16x16x32_bf16 v[44:47], v[60:63], v[200:203], v[44:47]
    ds_read_b128 v[52:55], v17 offset:17408
    s_waitcnt vmcnt(10)
    s_waitcnt lgkmcnt(4)
    v_mfma_f32_16x16x32_bf16 v[32:35], v[64:67], v[204:207], v[32:35]
    ds_read_b128 v[56:59], v17 offset:18432
    v_mfma_f32_16x16x32_bf16 v[36:39], v[68:71], v[204:207], v[36:39]
    ds_read_b128 v[60:63], v17 offset:19456
    buffer_load_dwordx4 v[120:123], v1, s[8:11], s54 offen offset:2048 sc1
    s_waitcnt lgkmcnt(4)
    v_mfma_f32_16x16x32_bf16 v[40:43], v[72:75], v[204:207], v[40:43]
    ds_read_b128 v[64:67], v17 offset:20480
    v_mfma_f32_16x16x32_bf16 v[44:47], v[76:79], v[204:207], v[44:47]
    ds_read_b128 v[68:71], v17 offset:21504
    s_waitcnt vmcnt(10)
    s_waitcnt lgkmcnt(4)
    v_mfma_f32_16x16x32_bf16 v[32:35], v[48:51], v[208:211], v[32:35]
    ds_read_b128 v[72:75], v17 offset:22528
    v_mfma_f32_16x16x32_bf16 v[36:39], v[52:55], v[208:211], v[36:39]
    ds_read_b128 v[76:79], v17 offset:23552
    buffer_load_dwordx4 v[124:127], v1, s[8:11], s54 offen offset:3072 sc1
    s_waitcnt lgkmcnt(4)
    v_mfma_f32_16x16x32_bf16 v[40:43], v[56:59], v[208:211], v[40:43]
    ds_read_b128 v[48:51], v17 offset:24576
    v_mfma_f32_16x16x32_bf16 v[44:47], v[60:63], v[208:211], v[44:47]
    ds_read_b128 v[52:55], v17 offset:25600
    s_waitcnt vmcnt(10)
    s_waitcnt lgkmcnt(4)
    v_mfma_f32_16x16x32_bf16 v[32:35], v[64:67], v[212:215], v[32:35]
    ds_read_b128 v[56:59], v17 offset:26624
    v_mfma_f32_16x16x32_bf16 v[36:39], v[68:71], v[212:215], v[36:39]
    ds_read_b128 v[60:63], v17 offset:27648
    s_add_u32 s54, s58, 40960
    buffer_load_dwordx4 v[128:131], v1, s[8:11], s54 offen sc1
    s_waitcnt lgkmcnt(4)
    v_mfma_f32_16x16x32_bf16 v[40:43], v[72:75], v[212:215], v[40:43]
    ds_read_b128 v[64:67], v17 offset:28672
    v_mfma_f32_16x16x32_bf16 v[44:47], v[76:79], v[212:215], v[44:47]
    ds_read_b128 v[68:71], v17 offset:29696
    s_waitcnt vmcnt(10)
    s_waitcnt lgkmcnt(4)
    v_mfma_f32_16x16x32_bf16 v[32:35], v[48:51], v[216:219], v[32:35]
    ds_read_b128 v[72:75], v17 offset:30720
    v_mfma_f32_16x16x32_bf16 v[36:39], v[52:55], v[216:219], v[36:39]
    ds_read_b128 v[76:79], v17 offset:31744
    buffer_load_dwordx4 v[132:135], v1, s[8:11], s54 offen offset:1024 sc1
    s_waitcnt lgkmcnt(4)
    v_mfma_f32_16x16x32_bf16 v[40:43], v[56:59], v[216:219], v[40:43]
    ds_read_b128 v[48:51], v17 offset:32768
    v_mfma_f32_16x16x32_bf16 v[44:47], v[60:63], v[216:219], v[44:47]
    ds_read_b128 v[52:55], v17 offset:33792
    s_waitcnt vmcnt(10)
    s_waitcnt lgkmcnt(4)
    v_mfma_f32_16x16x32_bf16 v[32:35], v[64:67], v[220:223], v[32:35]
    ds_read_b128 v[56:59], v17 offset:34816
    v_mfma_f32_16x16x32_bf16 v[36:39], v[68:71], v[220:223], v[36:39]
    ds_read_b128 v[60:63], v17 offset:35840
    buffer_load_dwordx4 v[136:139], v1, s[8:11], s54 offen offset:2048 sc1
    s_waitcnt lgkmcnt(4)
    v_mfma_f32_16x16x32_bf16 v[40:43], v[72:75], v[220:223], v[40:43]
    ds_read_b128 v[64:67], v17 offset:36864
    v_mfma_f32_16x16x32_bf16 v[44:47], v[76:79], v[220:223], v[44:47]
    ds_read_b128 v[68:71], v17 offset:37888
    s_waitcnt vmcnt(10)
    s_waitcnt lgkmcnt(4)
    v_mfma_f32_16x16x32_bf16 v[32:35], v[48:51], v[96:99], v[32:35]
    ds_read_b128 v[72:75], v17 offset:38912
    v_mfma_f32_16x16x32_bf16 v[36:39], v[52:55], v[96:99], v[36:39]
    ds_read_b128 v[76:79], v17 offset:39936
    s_waitcnt lgkmcnt(4)
    v_mfma_f32_16x16x32_bf16 v[40:43], v[56:59], v[96:99], v[40:43]
    ds_read_b128 v[48:51], v17 offset:40960
    v_mfma_f32_16x16x32_bf16 v[44:47], v[60:63], v[96:99], v[44:47]
    ds_read_b128 v[52:55], v17 offset:41984
    s_waitcnt vmcnt(9)
    s_waitcnt lgkmcnt(4)
    v_mfma_f32_16x16x32_bf16 v[32:35], v[64:67], v[100:103], v[32:35]
    ds_read_b128 v[56:59], v17 offset:43008
    v_mfma_f32_16x16x32_bf16 v[36:39], v[68:71], v[100:103], v[36:39]
    ds_read_b128 v[60:63], v17 offset:44032
    s_waitcnt lgkmcnt(4)
    v_mfma_f32_16x16x32_bf16 v[40:43], v[72:75], v[100:103], v[40:43]
    ds_read_b128 v[64:67], v17 offset:45056
    v_mfma_f32_16x16x32_bf16 v[44:47], v[76:79], v[100:103], v[44:47]
    ds_read_b128 v[68:71], v17 offset:46080
    s_waitcnt vmcnt(8)
    s_waitcnt lgkmcnt(4)
    v_mfma_f32_16x16x32_bf16 v[32:35], v[48:51], v[104:107], v[32:35]
    ds_read_b128 v[72:75], v17 offset:47104
    v_mfma_f32_16x16x32_bf16 v[36:39], v[52:55], v[104:107], v[36:39]
    ds_read_b128 v[76:79], v17 offset:48128
    s_waitcnt lgkmcnt(4)
    v_mfma_f32_16x16x32_bf16 v[40:43], v[56:59], v[104:107], v[40:43]
    ds_read_b128 v[48:51], v17 offset:49152
    v_mfma_f32_16x16x32_bf16 v[44:47], v[60:63], v[104:107], v[44:47]
    ds_read_b128 v[52:55], v17 offset:50176
    s_waitcnt vmcnt(7)
    s_waitcnt lgkmcnt(4)
    v_mfma_f32_16x16x32_bf16 v[32:35], v[64:67], v[108:111], v[32:35]
    ds_read_b128 v[56:59], v17 offset:51200
    v_mfma_f32_16x16x32_bf16 v[36:39], v[68:71], v[108:111], v[36:39]
    ds_read_b128 v[60:63], v17 offset:52224
    s_waitcnt lgkmcnt(4)
    v_mfma_f32_16x16x32_bf16 v[40:43], v[72:75], v[108:111], v[40:43]
    ds_read_b128 v[64:67], v17 offset:53248
    v_mfma_f32_16x16x32_bf16 v[44:47], v[76:79], v[108:111], v[44:47]
    ds_read_b128 v[68:71], v17 offset:54272
    s_waitcnt vmcnt(6)
    s_waitcnt lgkmcnt(4)
    v_mfma_f32_16x16x32_bf16 v[32:35], v[48:51], v[112:115], v[32:35]
    ds_read_b128 v[72:75], v17 offset:55296
    v_mfma_f32_16x16x32_bf16 v[36:39], v[52:55], v[112:115], v[36:39]
    ds_read_b128 v[76:79], v17 offset:56320
    s_waitcnt lgkmcnt(4)
    v_mfma_f32_16x16x32_bf16 v[40:43], v[56:59], v[112:115], v[40:43]
    ds_read_b128 v[48:51], v18 offset:16384
    v_mfma_f32_16x16x32_bf16 v[44:47], v[60:63], v[112:115], v[44:47]
    ds_read_b128 v[52:55], v18 offset:17408
    s_waitcnt vmcnt(5)
    s_waitcnt lgkmcnt(4)
    v_mfma_f32_16x16x32_bf16 v[32:35], v[64:67], v[116:119], v[32:35]
    ds_read_b128 v[56:59], v18 offset:18432
    v_mfma_f32_16x16x32_bf16 v[36:39], v[68:71], v[116:119], v[36:39]
    ds_read_b128 v[60:63], v18 offset:19456
    s_waitcnt lgkmcnt(4)
    v_mfma_f32_16x16x32_bf16 v[40:43], v[72:75], v[116:119], v[40:43]
    ds_read_b128 v[64:67], v18 offset:20480
    v_mfma_f32_16x16x32_bf16 v[44:47], v[76:79], v[116:119], v[44:47]
    ds_read_b128 v[68:71], v18 offset:21504
    s_waitcnt vmcnt(4)
    s_waitcnt lgkmcnt(4)
    v_mfma_f32_16x16x32_bf16 v[32:35], v[48:51], v[120:123], v[32:35]
    ds_read_b128 v[72:75], v18 offset:22528
    v_mfma_f32_16x16x32_bf16 v[36:39], v[52:55], v[120:123], v[36:39]
    ds_read_b128 v[76:79], v18 offset:23552
    s_waitcnt lgkmcnt(4)
    v_mfma_f32_16x16x32_bf16 v[40:43], v[56:59], v[120:123], v[40:43]
    ds_read_b128 v[48:51], v17 offset:57344
    v_mfma_f32_16x16x32_bf16 v[44:47], v[60:63], v[120:123], v[44:47]
    ds_read_b128 v[52:55], v17 offset:58368
    s_waitcnt vmcnt(3)
    s_waitcnt lgkmcnt(4)
    v_mfma_f32_16x16x32_bf16 v[32:35], v[64:67], v[124:127], v[32:35]
    ds_read_b128 v[56:59], v17 offset:59392
    v_mfma_f32_16x16x32_bf16 v[36:39], v[68:71], v[124:127], v[36:39]
    ds_read_b128 v[60:63], v17 offset:60416
    s_waitcnt lgkmcnt(4)
    v_mfma_f32_16x16x32_bf16 v[40:43], v[72:75], v[124:127], v[40:43]
    ds_read_b128 v[64:67], v17 offset:61440
    v_mfma_f32_16x16x32_bf16 v[44:47], v[76:79], v[124:127], v[44:47]
    ds_read_b128 v[68:71], v17 offset:62464
    s_waitcnt vmcnt(2)
    s_waitcnt lgkmcnt(4)
    v_mfma_f32_16x16x32_bf16 v[32:35], v[48:51], v[128:131], v[32:35]
    ds_read_b128 v[72:75], v17 offset:63488
    v_mfma_f32_16x16x32_bf16 v[36:39], v[52:55], v[128:131], v[36:39]
    ds_read_b128 v[76:79], v17 offset:64512
    s_waitcnt lgkmcnt(4)
    v_mfma_f32_16x16x32_bf16 v[40:43], v[56:59], v[128:131], v[40:43]
    ds_read_b128 v[48:51], v18 offset:0
    v_mfma_f32_16x16x32_bf16 v[44:47], v[60:63], v[128:131], v[44:47]
    ds_read_b128 v[52:55], v18 offset:1024
    s_waitcnt vmcnt(1)
    s_waitcnt lgkmcnt(4)
    v_mfma_f32_16x16x32_bf16 v[32:35], v[64:67], v[132:135], v[32:35]
    ds_read_b128 v[56:59], v18 offset:2048
    v_mfma_f32_16x16x32_bf16 v[36:39], v[68:71], v[132:135], v[36:39]
    ds_read_b128 v[60:63], v18 offset:3072
    s_waitcnt lgkmcnt(4)
    v_mfma_f32_16x16x32_bf16 v[40:43], v[72:75], v[132:135], v[40:43]
    v_mfma_f32_16x16x32_bf16 v[44:47], v[76:79], v[132:135], v[44:47]
    s_waitcnt vmcnt(0)
    s_waitcnt lgkmcnt(2)
    v_mfma_f32_16x16x32_bf16 v[32:35], v[48:51], v[136:139], v[32:35]
    v_mfma_f32_16x16x32_bf16 v[36:39], v[52:55], v[136:139], v[36:39]
    s_waitcnt lgkmcnt(0)
    v_mfma_f32_16x16x32_bf16 v[40:43], v[56:59], v[136:139], v[40:43]
    v_mfma_f32_16x16x32_bf16 v[44:47], v[60:63], v[136:139], v[44:47]
    s_waitcnt lgkmcnt(0)
    s_barrier
    v_lshlrev_b32 v80, 16, v2
    v_and_b32 v81, 0xffff0000, v2
    v_pk_add_f32 v[80:81], v[80:81], v[32:33]
    v_cvt_pk_bf16_f32 v2, v80, v81
    v_lshlrev_b32 v82, 16, v3
    v_and_b32 v83, 0xffff0000, v3
    v_pk_add_f32 v[82:83], v[82:83], v[34:35]
    v_cvt_pk_bf16_f32 v3, v82, v83
    v_lshlrev_b32 v84, 16, v4
    v_and_b32 v85, 0xffff0000, v4
    v_pk_add_f32 v[84:85], v[84:85], v[36:37]
    v_cvt_pk_bf16_f32 v4, v84, v85
    v_lshlrev_b32 v86, 16, v5
    v_and_b32 v87, 0xffff0000, v5
    v_pk_add_f32 v[86:87], v[86:87], v[38:39]
    v_cvt_pk_bf16_f32 v5, v86, v87
    v_lshlrev_b32 v80, 16, v6
    v_and_b32 v81, 0xffff0000, v6
    v_pk_add_f32 v[80:81], v[80:81], v[40:41]
    v_cvt_pk_bf16_f32 v6, v80, v81
    v_lshlrev_b32 v82, 16, v7
    v_and_b32 v83, 0xffff0000, v7
    v_pk_add_f32 v[82:83], v[82:83], v[42:43]
    v_cvt_pk_bf16_f32 v7, v82, v83
    v_lshlrev_b32 v84, 16, v8
    v_and_b32 v85, 0xffff0000, v8
    v_pk_add_f32 v[84:85], v[84:85], v[44:45]
    v_cvt_pk_bf16_f32 v8, v84, v85
    v_lshlrev_b32 v86, 16, v9
    v_and_b32 v87, 0xffff0000, v9
    v_pk_add_f32 v[86:87], v[86:87], v[46:47]
    v_cvt_pk_bf16_f32 v9, v86, v87
    s_cmp_lg_u32 s48, 0
    s_cbranch_scc1 L_final_71
    s_add_u32 s56, s49, 2097152
    s_add_u32 s57, s51, 25296896
    s_lshl_b32 s54, s63, 14
    s_lshl_b32 s55, s45, 11
    s_add_u32 s54, s54, s55
    s_add_u32 s54, s54, s56
    s_nop 7
    s_cmp_eq_u32 s99, 0
    s_cbranch_scc1 L_slow_72
    buffer_store_dwordx4 v[2:5], v1, s[8:11], s54 offen
    buffer_store_dwordx4 v[6:9], v1, s[8:11], s54 offen offset:1024
    s_branch L_join_73
L_slow_72:
    buffer_store_dwordx4 v[2:5], v1, s[8:11], s54 offen sc1
    buffer_store_dwordx4 v[6:9], v1, s[8:11], s54 offen offset:1024 sc1
L_join_73:
    s_nop 1
    v_mov_b32 v244, 0
    v_mov_b32 v245, 0
    v_mov_b32 v246, 0
    v_mov_b32 v247, 0
    v_dot2c_f32_bf16 v244, s62, v2
    v_dot2c_f32_bf16 v246, v2, v2
    v_dot2c_f32_bf16 v245, s62, v3
    v_dot2c_f32_bf16 v247, v3, v3
    v_dot2c_f32_bf16 v244, s62, v4
    v_dot2c_f32_bf16 v246, v4, v4
    v_dot2c_f32_bf16 v245, s62, v5
    v_dot2c_f32_bf16 v247, v5, v5
    v_dot2c_f32_bf16 v244, s62, v6
    v_dot2c_f32_bf16 v246, v6, v6
    v_dot2c_f32_bf16 v245, s62, v7
    v_dot2c_f32_bf16 v247, v7, v7
    v_dot2c_f32_bf16 v244, s62, v8
    v_dot2c_f32_bf16 v246, v8, v8
    v_dot2c_f32_bf16 v245, s62, v9
    v_dot2c_f32_bf16 v247, v9, v9
    v_lshlrev_b32 v240, 6, v15
    s_lshl_b32 s54, s63, 10
    s_lshl_b32 s55, s45, 3
    v_add_f32 v244, v244, v245
    v_add_f32 v245, v246, v247
    s_add_u32 s54, s54, s55
    s_add_u32 s54, s54, s57
    v_mov_b32 v242, v244
    v_mov_b32 v243, v245
    s_nop 0
    v_permlane16_swap_b32 v244, v242
    v_permlane16_swap_b32 v245, v243
    v_add_f32 v244, v244, v242
    v_add_f32 v245, v245, v243
    v_mov_b32 v242, v244
    v_mov_b32 v243, v245
    s_nop 0
    v_permlane32_swap_b32 v244, v242
    v_permlane32_swap_b32 v245, v243
    v_add_f32 v244, v244, v242
    v_add_f32 v245, v245, v243
    s_mov_b64 exec, s[78:79]
    s_nop 7
    s_cmp_eq_u32 s99, 0
    s_cbranch_scc1 L_slow_74
    buffer_store_dwordx2 v[244:245], v240, s[8:11], s54 offen
    s_branch L_join_75
L_slow_74:
    buffer_store_dwordx2 v[244:245], v240, s[8:11], s54 offen sc1
L_join_75:
    s_nop 1
    s_mov_b64 exec, -1
    s_cmp_eq_u32 s101, 0
    s_cbranch_scc1 L_nohc_76
    s_lshr_b32 s54, s44, 2
    s_lshl_b32 s55, s54, 14
    s_lshl_b32 s56, s45, 11
    s_add_u32 s55, s55, s56
    s_add_u32 s55, s55, 26476544
    buffer_store_dwordx4 v[2:5], v1, s[8:11], s55 offen sc1
    buffer_store_dwordx4 v[6:9], v1, s[8:11], s55 offen offset:1024 sc1
    s_lshl_b32 s55, s54, 10
    s_lshl_b32 s56, s45, 3
    s_add_u32 s55, s55, s56
    s_add_u32 s55, s55, 26615808
    s_mov_b64 exec, s[78:79]
    buffer_store_dwordx2 v[244:245], v240, s[8:11], s55 offen sc1
    s_mov_b64 exec, -1
L_nohc_76:
    s_nop 1
    v_lshrrev_b32 v168, 4, v15
    v_bfe_u32 v169, v15, 2, 2
    v_and_b32 v170, 1, v168
    v_lshl_add_u32 v170, v170, 2, v169
    v_and_b32 v169, 6, v170
    s_lshl_b32 s54, s46, 1
    v_xor_b32 v169, s54, v169
    v_bfe_u32 v16, v15, 1, 1
    v_or_b32 v169, v169, v16
    v_lshlrev_b32 v169, 4, v169
    v_lshl_add_u32 v169, v170, 7, v169
    v_lshrrev_b32 v168, 1, v168
    v_mul_u32_u24 v168, 3072, v168
    v_add_u32 v169, v169, v168
    v_and_b32 v168, 1, v15
    v_lshl_add_u32 v16, v168, 3, v169
    v_add_u32 v17, 0x10000, v16
    v_add_u32 v18, 73728, v1
    v_add_u32 v19, 139264, v1
    v_mov_b32 v164, 0x3f803f80
    v_mov_b32 v40, 0
    v_mov_b32 v41, 0
    v_mov_b32 v42, 0
    v_mov_b32 v43, 0
    v_mov_b32 v44, 0
    v_mov_b32 v45, 0
    v_mov_b32 v46, 0
    v_mov_b32 v47, 0
    v_mov_b32 v48, 0
    v_mov_b32 v49, 0
    v_mov_b32 v50, 0
    v_mov_b32 v51, 0
    v_mov_b32 v52, 0
    v_mov_b32 v53, 0
    v_mov_b32 v54, 0
    v_mov_b32 v55, 0
    v_mov_b32 v56, 0
    v_mov_b32 v57, 0
    v_mov_b32 v58, 0
    v_mov_b32 v59, 0
    v_mov_b32 v60, 0
    v_mov_b32 v61, 0
    v_mov_b32 v62, 0
    v_mov_b32 v63, 0
    v_mov_b32 v64, 0
    v_mov_b32 v65, 0
    v_mov_b32 v66, 0
    v_mov_b32 v67, 0
    v_mov_b32 v68, 0
    v_mov_b32 v69, 0
    v_mov_b32 v70, 0
    v_mov_b32 v71, 0
    v_mov_b32 v72, 0
    v_mov_b32 v73, 0
    v_mov_b32 v74, 0
    v_mov_b32 v75, 0
    v_mov_b32 v76, 0
    v_mov_b32 v77, 0
    v_mov_b32 v78, 0
    v_mov_b32 v79, 0
    v_mov_b32 v80, 0
    v_mov_b32 v81, 0
    v_mov_b32 v82, 0
    v_mov_b32 v83, 0
    v_mov_b32 v84, 0
    v_mov_b32 v85, 0
    v_mov_b32 v86, 0
    v_mov_b32 v87, 0
    v_mov_b32 v88, 0
    v_mov_b32 v89, 0
    v_mov_b32 v90, 0
    v_mov_b32 v91, 0
    v_mov_b32 v92, 0
    v_mov_b32 v93, 0
    v_mov_b32 v94, 0
    v_mov_b32 v95, 0
    v_mov_b32 v96, 0
    v_mov_b32 v97, 0
    v_mov_b32 v98, 0
    v_mov_b32 v99, 0
    v_and_b32 v166, 15, v15
    v_lshlrev_b32 v166, 6, v166
    v_lshrrev_b32 v168, 4, v15
    v_lshl_add_u32 v166, v168, 4, v166
    v_and_b32 v168, 1, v15
    v_cmp_eq_u32 vcc, 0, v168
    v_mov_b32 v169, 0xff61b1e6
    s_nop 0
    v_cndmask_b32 v230, v169, 0, vcc
    v_cndmask_b32 v231, 0, v169, vcc
    v_mov_b32 v232, v230
    v_mov_b32 v233, v231
    s_cmp_eq_u32 s44, 0
    s_cselect_b32 s54, 0xff61b1e6, 0
    v_mov_b32 v168, s54
    v_cndmask_b32 v168, v168, 0, s[64:65]
    v_min_f32 v234, v168, v230
    v_mov_b32 v168, s54
    v_cndmask_b32 v168, v168, 0, s[66:67]
    v_min_f32 v235, v168, v231
    v_mov_b32 v168, s54
    v_cndmask_b32 v168, v168, 0, s[68:69]
    v_min_f32 v236, v168, v232
    v_mov_b32 v168, s54
    v_cndmask_b32 v168, v168, 0, s[70:71]
    v_min_f32 v237, v168, v233
    v_and_b32 v250, 7, v15
    s_lshr_b32 s54, s44, 2
    s_lshl_b32 s54, s54, 3
    s_add_u32 s54, s54, 16376
    s_lshl_b32 s55, s44, 3
    s_sub_u32 s56, s55, 8
    s_and_b32 s57, s44, 3
    s_cmp_eq_u32 s57, 0
    s_cselect_b32 s56, s54, s56
    s_cmp_eq_u32 s44, 0
    s_cselect_b32 s56, s55, s56
    v_add_u32 v251, s55, v250
    v_add_u32 v250, s56, v250
    v_and_b32 v249, 8, v15
    v_cmp_eq_u32 vcc, 0, v249
    s_nop 1
    v_cndmask_b32 v251, v250, v251, vcc
    v_lshlrev_b32 v251, 2, v251
    s_waitcnt vmcnt(0)
    s_barrier
    s_cmp_eq_u32 s101, 0
    s_cbranch_scc1 L_nohalo_77
    s_waitcnt vmcnt(0)
    s_lshr_b32 s54, s44, 2
    s_lshl_b32 s54, s54, 3
    s_add_u32 s54, s54, s45
    s_lshl_b32 s54, s54, 2
    s_add_u32 s54, s54, s52
    s_add_u32 s54, s54, 26284032
    s_mov_b64 s[92:93], exec
    s_mov_b64 exec, 1
    v_mov_b32 v252, 0
    v_mov_b32 v253, s47
    buffer_store_dword v253, v252, s[8:11], s54 offen sc1
    s_mov_b64 exec, s[92:93]
L_nohalo_77:
    s_nop 1
    s_cmp_lg_u32 s46, 0
    s_cbranch_scc1 L_w0skip_78
    s_lshl_b32 s54, s44, 3
    s_add_u32 s54, s54, s45
    s_lshl_b32 s54, s54, 2
    s_add_u32 s54, s54, s52
    s_add_u32 s54, s54, 26218496
    s_mov_b64 s[92:93], exec
    s_mov_b64 exec, 1
    v_mov_b32 v252, 0
    v_mov_b32 v253, s47
    s_cmp_eq_u32 s99, 0
    s_cbranch_scc1 L_fslow_79
    buffer_store_dword v253, v252, s[8:11], s54 offen
    s_branch L_fjoin_80
L_fslow_79:
    buffer_store_dword v253, v252, s[8:11], s54 offen sc1
L_fjoin_80:
    s_mov_b64 exec, s[92:93]
    s_add_u32 s54, s52, 26218496
    s_mov_b32 s83, 0
L_poll_81:
    buffer_load_dword v253, v251, s[8:11], s54 offen sc1
    s_waitcnt vmcnt(0)
    s_waitcnt vmcnt(0)
    v_and_b32 v252, -16, v253
    v_cmp_ne_u32 vcc, s47, v252
    s_nop 3
    s_cmp_eq_u64 vcc, 0
    s_cbranch_scc1 L_pdone_82
    s_add_u32 s83, s83, 1
    s_cmp_lt_u32 s83, 200000
    s_cbranch_scc1 L_poll_81
L_pdone_82:
L_w0skip_78:
    s_nop 3
    s_mov_b32 s48, 1
    s_mov_b32 s49, 0x200000
    s_mov_b32 s50, 0x600000
    s_mov_b32 s51, 0x20000
    s_mov_b32 s52, 0x1000
    s_branch L_layer
L_final_71:
    s_nop 3
    v_and_b32 v80, 15, v15
    v_lshlrev_b32 v80, 10, v80
    v_lshrrev_b32 v81, 4, v15
    v_lshlrev_b32 v81, 3, v81
    v_add_u32 v80, v80, v81
    s_lshl_b32 s53, s63, 14
    s_lshl_b32 s54, s45, 7
    s_add_u32 s53, s53, s54
    buffer_store_dwordx2 v[2:3], v80, s[36:39], s53 offen offset:0
    buffer_store_dwordx2 v[4:5], v80, s[36:39], s53 offen offset:32
    buffer_store_dwordx2 v[6:7], v80, s[36:39], s53 offen offset:64
    buffer_store_dwordx2 v[8:9], v80, s[36:39], s53 offen offset:96
L_end:
    s_endpgm
L_loader:
    s_nop 1
    v_lshrrev_b32 v20, 3, v15
    v_and_b32 v21, 6, v20
    v_and_b32 v22, 7, v15
    v_xor_b32 v22, v22, v21
    v_lshlrev_b32 v22, 4, v22
    s_lshl_b32 s53, s45, 7
    v_add_u32 v22, s53, v22
    s_lshl_b32 s54, s46, 3
    v_add_u32 v20, s54, v20
    v_mul_u32_u24 v21, 3072, v20
    v_add_u32 v10, v21, v22
    v_lshlrev_b32 v21, 10, v20
    v_add_u32 v11, v21, v22
    v_add_u32 v16, s60, v1
    s_add_u32 s53, s61, 73728
    v_add_u32 v120, s53, v1
    v_mov_b32 v122, 0x3f803f80
    v_mov_b32 v123, 0x3f803f80
    v_mov_b32 v124, 0x3f803f80
    v_mov_b32 v125, 0x3f803f80
    s_mov_b32 s76, 0x00010001
    s_mov_b32 s77, 0x00010001
    s_mov_b32 s28, s8
    s_mov_b32 s29, s9
    s_mov_b32 s30, 0
    s_mov_b32 s31, 0x20000
    v_mov_b32 v126, 0
    v_mov_b32 v45, 0
    v_mov_b32 v50, 0
    v_mov_b32 v54, 0
    v_mov_b32 v115, 0
    v_lshrrev_b32 v20, 4, v15
    v_lshlrev_b32 v20, 10, v20
    v_and_b32 v21, 15, v15
    v_lshl_add_u32 v20, v21, 4, v20
    s_lshl_b32 s53, s46, 8
    v_add_u32 v20, s53, v20
    s_lshl_b32 s54, s44, 16
    s_sub_u32 s54, s54, 16384
    s_lshl_b32 s55, s90, 14
    s_add_u32 s96, s55, 0
    buffer_load_dwordx4 v[130:133], v20, s[12:15], s96 offen
    s_add_u32 s96, s55, 4096
    buffer_load_dwordx4 v[134:137], v20, s[12:15], s96 offen
    s_add_u32 s96, s55, 8192
    buffer_load_dwordx4 v[138:141], v20, s[12:15], s96 offen
    s_add_u32 s96, s55, 12288
    buffer_load_dwordx4 v[142:145], v20, s[12:15], s96 offen
    s_add_u32 s96, s54, 16384
    buffer_load_dwordx4 v[146:149], v20, s[12:15], s96 offen
    s_add_u32 s96, s54, 20480
    buffer_load_dwordx4 v[150:153], v20, s[12:15], s96 offen
    s_add_u32 s96, s54, 24576
    buffer_load_dwordx4 v[154:157], v20, s[12:15], s96 offen
    s_add_u32 s96, s54, 28672
    buffer_load_dwordx4 v[158:161], v20, s[12:15], s96 offen
    s_add_u32 s96, s54, 32768
    buffer_load_dwordx4 v[162:165], v20, s[12:15], s96 offen
    s_add_u32 s96, s54, 36864
    buffer_load_dwordx4 v[166:169], v20, s[12:15], s96 offen
    s_add_u32 s96, s54, 40960
    buffer_load_dwordx4 v[170:173], v20, s[12:15], s96 offen
    s_add_u32 s96, s54, 45056
    buffer_load_dwordx4 v[174:177], v20, s[12:15], s96 offen
    s_add_u32 s96, s54, 49152
    buffer_load_dwordx4 v[178:181], v20, s[12:15], s96 offen
    s_add_u32 s96, s54, 53248
    buffer_load_dwordx4 v[182:185], v20, s[12:15], s96 offen
    s_add_u32 s96, s54, 57344
    buffer_load_dwordx4 v[186:189], v20, s[12:15], s96 offen
    s_add_u32 s96, s54, 61440
    buffer_load_dwordx4 v[190:193], v20, s[12:15], s96 offen
    s_add_u32 s96, s54, 65536
    buffer_load_dwordx4 v[194:197], v20, s[12:15], s96 offen
    s_add_u32 s96, s54, 69632
    buffer_load_dwordx4 v[198:201], v20, s[12:15], s96 offen
    s_add_u32 s96, s54, 73728
    buffer_load_dwordx4 v[202:205], v20, s[12:15], s96 offen
    s_add_u32 s96, s54, 77824
    buffer_load_dwordx4 v[206:209], v20, s[12:15], s96 offen
    s_add_u32 m0, s59, 0
    s_mov_b32 s96, 0
    buffer_load_dwordx4 v10, s[16:19], s96 offen lds
    buffer_load_dwordx4 v10, s[16:19], s96 offen offset:1024 lds
    buffer_load_dwordx4 v10, s[16:19], s96 offen offset:2048 lds
    s_add_u32 m0, s59, 12288
    s_mov_b32 s96, 98304
    buffer_load_dwordx4 v10, s[16:19], s96 offen lds
    buffer_load_dwordx4 v10, s[16:19], s96 offen offset:1024 lds
    buffer_load_dwordx4 v10, s[16:19], s96 offen offset:2048 lds
    s_add_u32 m0, s59, 24576
    s_mov_b32 s96, 196608
    buffer_load_dwordx4 v10, s[16:19], s96 offen lds
    buffer_load_dwordx4 v10, s[16:19], s96 offen offset:1024 lds
    buffer_load_dwordx4 v10, s[16:19], s96 offen offset:2048 lds
    s_add_u32 m0, s59, 36864
    s_mov_b32 s96, 294912
    buffer_load_dwordx4 v10, s[16:19], s96 offen lds
    buffer_load_dwordx4 v10, s[16:19], s96 offen offset:1024 lds
    buffer_load_dwordx4 v10, s[16:19], s96 offen offset:2048 lds
    s_add_u32 m0, s59, 49152
    s_mov_b32 s96, 393216
    buffer_load_dwordx4 v10, s[16:19], s96 offen lds
    buffer_load_dwordx4 v10, s[16:19], s96 offen offset:1024 lds
    buffer_load_dwordx4 v10, s[16:19], s96 offen offset:2048 lds
    s_add_u32 m0, s59, 61440
    s_mov_b32 s96, 491520
    buffer_load_dwordx4 v10, s[16:19], s96 offen lds
    buffer_load_dwordx4 v10, s[16:19], s96 offen offset:1024 lds
    buffer_load_dwordx4 v10, s[16:19], s96 offen offset:2048 lds
    s_lshl_b32 s64, s45, 16
    s_add_u32 s64, s64, 29360128
    s_lshl_b32 s65, s80, 16
    s_add_u32 s65, s65, 33554432
    s_mul_i32 s66, s45, 176128
    s_add_u32 s66, s66, 29884416
    s_cmp_lt_u32 s2, 86
    s_cbranch_scc1 L_shA_1
    s_cmp_lt_u32 s2, 204
    s_cbranch_scc1 L_shB_2
    s_branch L_shE_3
L_shA_1:
    s_and_b32 s53, s2, 1
    s_cmp_eq_u32 s53, 0
    s_cselect_b32 s24, s72, s74
    s_cselect_b32 s54, s73, s75
    s_and_b32 s25, s54, 0xffff
    s_mov_b32 s26, 1409024
    s_mov_b32 s27, 0x20000
    v_lshrrev_b32 v24, 2, v15
    v_mul_u32_u24 v24, 2752, v24
    v_and_b32 v25, 3, v15
    v_lshl_add_u32 v24, v25, 4, v24
    s_lshr_b32 s67, s2, 1
    s_lshl_b32 s54, s67, 6
    s_mul_i32 s55, s46, 88064
    s_add_u32 s54, s54, s55
    s_lshl_b32 s55, s46, 11
    s_add_u32 m0, s55, 114688
    s_add_u32 s96, s54, 0
    buffer_load_dwordx4 v24, s[24:27], s96 offen lds
    s_add_u32 m0, s55, 115712
    s_add_u32 s96, s54, 44032
    buffer_load_dwordx4 v24, s[24:27], s96 offen lds
    s_add_u32 m0, s55, 122880
    s_add_u32 s96, s54, 352256
    buffer_load_dwordx4 v24, s[24:27], s96 offen lds
    s_add_u32 m0, s55, 123904
    s_add_u32 s96, s54, 396288
    buffer_load_dwordx4 v24, s[24:27], s96 offen lds
    s_add_u32 m0, s55, 131072
    s_add_u32 s96, s54, 704512
    buffer_load_dwordx4 v24, s[24:27], s96 offen lds
    s_add_u32 m0, s55, 132096
    s_add_u32 s96, s54, 748544
    buffer_load_dwordx4 v24, s[24:27], s96 offen lds
    s_add_u32 m0, s55, 139264
    s_add_u32 s96, s54, 1056768
    buffer_load_dwordx4 v24, s[24:27], s96 offen lds
    s_add_u32 m0, s55, 140288
    s_add_u32 s96, s54, 1100800
    buffer_load_dwordx4 v24, s[24:27], s96 offen lds
    v_lshrrev_b32 v25, 5, v15
    v_bfe_u32 v26, v15, 2, 2
    v_lshl_add_u32 v25, v25, 2, v26
    v_lshlrev_b32 v25, 6, v25
    v_bfe_u32 v26, v15, 4, 1
    v_lshl_add_u32 v25, v26, 5, v25
    v_and_b32 v26, 3, v15
    v_lshl_add_u32 v25, v26, 3, v25
    s_add_u32 s55, s55, 114688
    v_add_u32 v25, s55, v25
    s_lshl_b32 s54, s67, 16
    s_and_b32 s53, s2, 1
    s_lshl_b32 s53, s53, 10
    s_add_u32 s54, s54, s53
    s_lshl_b32 s53, s46, 12
    s_add_u32 s54, s54, s53
    s_add_u32 s67, s54, 33554432
    s_branch L_shE_3
L_shB_2:
    s_sub_u32 s53, s2, 86
    s_lshl_b32 s53, s53, 2
    s_add_u32 s53, s53, s46
    s_sub_u32 s54, s53, 128
    s_mul_i32 s55, s54, 1525
    s_lshr_b32 s55, s55, 16
    s_mul_i32 s56, s55, 43
    s_sub_u32 s56, s54, s56
    s_lshr_b32 s57, s53, 4
    s_and_b32 s58, s53, 15
    s_lshl_b32 s67, s53, 12
    s_add_u32 s67, s67, 29360128
    s_lshl_b32 s68, s54, 12
    s_add_u32 s68, s68, 29884416
    s_cmp_lt_u32 s53, 128
    s_cselect_b32 s55, s57, s55
    s_cselect_b32 s56, s58, s56
    s_cselect_b32 s67, s67, s68
    s_cselect_b32 s24, s20, s32
    s_cselect_b32 s25, s21, s33
    s_cselect_b32 s26, s22, s34
    s_cselect_b32 s69, 10, 11
    s_cselect_b32 s70, 2, 1
    s_lshl_b32 s70, s70, 10
    s_mov_b32 s27, 0x20000
    s_lshl_b32 s56, s56, 15
    s_lshl_b32 s55, s55, 7
    s_add_u32 s56, s56, s55
    v_lshrrev_b32 v24, 3, v15
    v_and_b32 v25, 6, v24
    v_and_b32 v26, 7, v15
    v_xor_b32 v26, v26, v25
    v_lshlrev_b32 v26, 4, v26
    v_lshl_add_u32 v24, v24, 10, v26
    s_lshl_b32 s55, s46, 12
    s_add_u32 m0, s55, 114688
    s_add_u32 s96, s56, 0
    buffer_load_dwordx4 v24, s[24:27], s96 offen lds
    s_add_u32 m0, s55, 115712
    s_add_u32 s96, s56, 8192
    buffer_load_dwordx4 v24, s[24:27], s96 offen lds
    s_add_u32 m0, s55, 116736
    s_add_u32 s96, s56, 16384
    buffer_load_dwordx4 v24, s[24:27], s96 offen lds
    s_add_u32 m0, s55, 117760
    s_add_u32 s96, s56, 24576
    buffer_load_dwordx4 v24, s[24:27], s96 offen lds
    v_lshrrev_b32 v56, 4, v15
    v_bfe_u32 v57, v15, 2, 2
    v_and_b32 v26, 1, v56
    v_lshl_add_u32 v26, v26, 2, v57
    v_and_b32 v58, 6, v26
    v_lshlrev_b32 v26, 7, v26
    v_lshrrev_b32 v56, 1, v56
    v_lshlrev_b32 v56, s69, v56
    v_add_u32 v26, v26, v56
    v_and_b32 v57, 1, v15
    v_lshl_add_u32 v26, v57, 3, v26
    s_add_u32 s55, s55, 114688
    v_add_u32 v26, s55, v26
    v_bfe_u32 v57, v15, 1, 1
    v_xor_b32 v59, 0, v58
    v_or_b32 v59, v59, v57
    v_lshl_add_u32 v60, v59, 4, v26
    v_add_u32 v61, s70, v60
    v_xor_b32 v59, 2, v58
    v_or_b32 v59, v59, v57
    v_lshl_add_u32 v62, v59, 4, v26
    v_add_u32 v63, s70, v62
    v_xor_b32 v59, 4, v58
    v_or_b32 v59, v59, v57
    v_lshl_add_u32 v64, v59, 4, v26
    v_add_u32 v65, s70, v64
    v_xor_b32 v59, 6, v58
    v_or_b32 v59, v59, v57
    v_lshl_add_u32 v66, v59, 4, v26
    v_add_u32 v67, s70, v66
L_shE_3:
    s_nop 1
    v_bfe_u32 v20, v15, 2, 2
    v_mul_u32_u24 v20, 5120, v20
    v_lshrrev_b32 v21, 4, v15
    v_lshl_add_u32 v20, v21, 4, v20
    v_and_b32 v21, 1, v15
    v_lshl_add_u32 v20, v21, 9, v20
    v_bfe_u32 v21, v15, 1, 1
    v_lshl_add_u32 v20, v21, 3, v20
    s_mul_i32 s53, s46, 20480
    s_add_u32 s53, s53, 73728
    v_add_u32 v119, s53, v20
    s_cmp_gt_u32 s46, 1
    s_cbranch_scc1 L_x0late_4
    v_cmp_gt_u32 vcc, 16, v15
    s_waitcnt vmcnt(37)
    s_nop 0
    v_cndmask_b32 v130, v130, v122, vcc
    v_cndmask_b32 v131, v131, v122, vcc
    v_cndmask_b32 v132, v132, v122, vcc
    v_cndmask_b32 v133, v133, v122, vcc
    ds_write_b64 v119, v[130:131] offset:0
    ds_write_b64 v119, v[132:133] offset:256
    s_waitcnt vmcnt(36)
    ds_write_b64 v119, v[134:135] offset:64
    ds_write_b64 v119, v[136:137] offset:320
    s_waitcnt vmcnt(35)
    ds_write_b64 v119, v[138:139] offset:128
    ds_write_b64 v119, v[140:141] offset:384
    s_waitcnt vmcnt(34)
    ds_write_b64 v119, v[142:143] offset:192
    ds_write_b64 v119, v[144:145] offset:448
    s_waitcnt vmcnt(33)
    ds_write_b64 v119, v[146:147] offset:1024
    ds_write_b64 v119, v[148:149] offset:1280
    s_waitcnt vmcnt(32)
    ds_write_b64 v119, v[150:151] offset:1088
    ds_write_b64 v119, v[152:153] offset:1344
    s_waitcnt vmcnt(31)
    ds_write_b64 v119, v[154:155] offset:1152
    ds_write_b64 v119, v[156:157] offset:1408
    s_waitcnt vmcnt(30)
    ds_write_b64 v119, v[158:159] offset:1216
    ds_write_b64 v119, v[160:161] offset:1472
    s_waitcnt vmcnt(29)
    ds_write_b64 v119, v[162:163] offset:2048
    ds_write_b64 v119, v[164:165] offset:2304
    s_waitcnt vmcnt(28)
    ds_write_b64 v119, v[166:167] offset:2112
    ds_write_b64 v119, v[168:169] offset:2368
    s_waitcnt vmcnt(27)
    ds_write_b64 v119, v[170:171] offset:2176
    ds_write_b64 v119, v[172:173] offset:2432
    s_waitcnt vmcnt(26)
    ds_write_b64 v119, v[174:175] offset:2240
    ds_write_b64 v119, v[176:177] offset:2496
    s_waitcnt vmcnt(25)
    ds_write_b64 v119, v[178:179] offset:3072
    ds_write_b64 v119, v[180:181] offset:3328
    s_waitcnt vmcnt(24)
    ds_write_b64 v119, v[182:183] offset:3136
    ds_write_b64 v119, v[184:185] offset:3392
    s_waitcnt vmcnt(23)
    ds_write_b64 v119, v[186:187] offset:3200
    ds_write_b64 v119, v[188:189] offset:3456
    s_waitcnt vmcnt(22)
    ds_write_b64 v119, v[190:191] offset:3264
    ds_write_b64 v119, v[192:193] offset:3520
    s_waitcnt vmcnt(21)
    ds_write_b64 v119, v[194:195] offset:4096
    ds_write_b64 v119, v[196:197] offset:4352
    s_waitcnt vmcnt(20)
    ds_write_b64 v119, v[198:199] offset:4160
    ds_write_b64 v119, v[200:201] offset:4416
    s_waitcnt vmcnt(19)
    ds_write_b64 v119, v[202:203] offset:4224
    ds_write_b64 v119, v[204:205] offset:4480
    s_waitcnt vmcnt(18)
    ds_write_b64 v119, v[206:207] offset:4288
    ds_write_b64 v119, v[208:209] offset:4544
    s_waitcnt lgkmcnt(0)
L_x0late_4:
    s_nop 1
    s_cmp_lg_u32 s46, 2
    s_cbranch_scc1 L_lnn_5
    s_mov_b32 s83, 0
L_lnp_6:
    buffer_load_dword v21, v126, s[40:43], 0 offen sc1
    s_waitcnt vmcnt(0)
    s_waitcnt vmcnt(0)
    v_readfirstlane_b32 s47, v21
    s_nop 3
    s_cmp_lg_u32 s47, 0
    s_cbranch_scc1 L_lnd_7
    s_add_u32 s83, s83, 1
    s_cmp_lt_u32 s83, 200000
    s_cbranch_scc1 L_lnp_6
L_lnd_7:
    v_mov_b32 v22, 159744
    ds_write_b32 v22, v21 offset:4
L_lnn_5:
    s_nop 1
    s_waitcnt lgkmcnt(0)
L_llayer:
    s_nop 1
    s_lshl_b32 s97, s90, 14
    s_add_u32 s97, s97, s49
    s_lshr_b32 s54, s44, 2
    s_lshl_b32 s54, s54, 14
    s_lshr_b32 s55, s49, 4
    s_add_u32 s54, s54, s55
    s_add_u32 s54, s54, 26329088
    s_and_b32 s55, s44, 3
    s_cmp_eq_u32 s55, 0
    s_cselect_b32 s54, s54, s97
    s_cmp_eq_u32 s44, 0
    s_cselect_b32 s97, s97, s54
    s_lshl_b32 s98, s44, 16
    s_add_u32 s98, s98, s49
    s_lshl_b32 s54, s90, 10
    s_add_u32 s54, s54, s51
    s_add_u32 s54, s54, 25165824
    s_lshr_b32 s55, s44, 2
    s_lshl_b32 s55, s55, 10
    s_lshr_b32 s56, s49, 8
    s_add_u32 s55, s55, s56
    s_add_u32 s55, s55, 26606592
    s_and_b32 s56, s44, 3
    s_cmp_eq_u32 s56, 0
    s_cselect_b32 s55, s55, s54
    s_cmp_eq_u32 s44, 0
    s_cselect_b32 s54, s54, s55
    s_lshl_b32 s55, s44, 12
    s_add_u32 s55, s55, s51
    s_add_u32 s55, s55, 25165824
    s_cmp_eq_u32 s46, 0
    s_cselect_b32 s71, s55, s54
    s_cselect_b32 s56, 63, 15
    s_cselect_b32 s57, 64, 0
    s_add_u32 s57, s57, 155648
    v_and_b32 v41, s56, v15
    v_lshlrev_b32 v40, 6, v41
    v_lshlrev_b32 v41, 2, v41
    v_add_u32 v41, s57, v41
    s_barrier
    s_cmp_eq_u32 s48, 0
    s_cbranch_scc1 L_x0path_15
    s_add_u32 m0, s61, 73728
    s_add_u32 s96, s97, 0
    buffer_load_dwordx4 v16, s[8:11], s96 offen sc1 lds
    s_add_u32 m0, s61, 74752
    s_add_u32 s96, s98, 0
    buffer_load_dwordx4 v16, s[8:11], s96 offen sc1 lds
    s_add_u32 m0, s61, 75776
    s_add_u32 s96, s98, 16384
    buffer_load_dwordx4 v16, s[8:11], s96 offen sc1 lds
    s_add_u32 m0, s61, 76800
    s_add_u32 s96, s98, 32768
    buffer_load_dwordx4 v16, s[8:11], s96 offen sc1 lds
    s_add_u32 m0, s61, 77824
    s_add_u32 s96, s98, 49152
    buffer_load_dwordx4 v16, s[8:11], s96 offen sc1 lds
    s_cmp_gt_u32 s46, 1
    s_cbranch_scc1 L_nostat_17
    buffer_load_dwordx4 v[20:23], v40, s[8:11], s71 offen offset:0 sc1
    buffer_load_dwordx4 v[24:27], v40, s[8:11], s71 offen offset:16 sc1
    buffer_load_dwordx4 v[28:31], v40, s[8:11], s71 offen offset:32 sc1
    buffer_load_dwordx4 v[32:35], v40, s[8:11], s71 offen offset:48 sc1
L_nostat_17:
    s_nop 1
    s_add_u32 m0, s61, 94208
    s_add_u32 s96, s97, 4096
    buffer_load_dwordx4 v16, s[8:11], s96 offen sc1 lds
    s_add_u32 m0, s61, 95232
    s_add_u32 s96, s98, 4096
    buffer_load_dwordx4 v16, s[8:11], s96 offen sc1 lds
    s_add_u32 m0, s61, 96256
    s_add_u32 s96, s98, 20480
    buffer_load_dwordx4 v16, s[8:11], s96 offen sc1 lds
    s_add_u32 m0, s61, 97280
    s_add_u32 s96, s98, 36864
    buffer_load_dwordx4 v16, s[8:11], s96 offen sc1 lds
    s_add_u32 m0, s61, 98304
    s_add_u32 s96, s98, 53248
    buffer_load_dwordx4 v16, s[8:11], s96 offen sc1 lds
    s_add_u32 m0, s61, 114688
    s_add_u32 s96, s97, 8192
    buffer_load_dwordx4 v16, s[8:11], s96 offen sc1 lds
    s_add_u32 m0, s61, 115712
    s_add_u32 s96, s98, 8192
    buffer_load_dwordx4 v16, s[8:11], s96 offen sc1 lds
    s_add_u32 m0, s61, 116736
    s_add_u32 s96, s98, 24576
    buffer_load_dwordx4 v16, s[8:11], s96 offen sc1 lds
    s_add_u32 m0, s61, 117760
    s_add_u32 s96, s98, 40960
    buffer_load_dwordx4 v16, s[8:11], s96 offen sc1 lds
    s_add_u32 m0, s61, 118784
    s_add_u32 s96, s98, 57344
    buffer_load_dwordx4 v16, s[8:11], s96 offen sc1 lds
    s_add_u32 m0, s61, 135168
    s_add_u32 s96, s97, 12288
    buffer_load_dwordx4 v16, s[8:11], s96 offen sc1 lds
    s_add_u32 m0, s61, 136192
    s_add_u32 s96, s98, 12288
    buffer_load_dwordx4 v16, s[8:11], s96 offen sc1 lds
    s_add_u32 m0, s61, 137216
    s_add_u32 s96, s98, 28672
    buffer_load_dwordx4 v16, s[8:11], s96 offen sc1 lds
    s_add_u32 m0, s61, 138240
    s_add_u32 s96, s98, 45056
    buffer_load_dwordx4 v16, s[8:11], s96 offen sc1 lds
    s_add_u32 m0, s61, 139264
    s_add_u32 s96, s98, 61440
    buffer_load_dwordx4 v16, s[8:11], s96 offen sc1 lds
    s_branch L_x0join_16
L_x0path_15:
    buffer_load_dword v127, v126, s[28:31], 0 offen
    buffer_load_dword v127, v126, s[28:31], 0 offen
    buffer_load_dword v127, v126, s[28:31], 0 offen
    buffer_load_dword v127, v126, s[28:31], 0 offen
    buffer_load_dword v127, v126, s[28:31], 0 offen
    buffer_load_dword v127, v126, s[28:31], 0 offen
    buffer_load_dword v127, v126, s[28:31], 0 offen
    buffer_load_dword v127, v126, s[28:31], 0 offen
    buffer_load_dword v127, v126, s[28:31], 0 offen
    buffer_load_dword v127, v126, s[28:31], 0 offen
    buffer_load_dword v127, v126, s[28:31], 0 offen
    buffer_load_dword v127, v126, s[28:31], 0 offen
    buffer_load_dword v127, v126, s[28:31], 0 offen
    buffer_load_dword v127, v126, s[28:31], 0 offen
    buffer_load_dword v127, v126, s[28:31], 0 offen
    buffer_load_dword v127, v126, s[28:31], 0 offen
    buffer_load_dword v127, v126, s[28:31], 0 offen
    buffer_load_dword v127, v126, s[28:31], 0 offen
    buffer_load_dword v127, v126, s[28:31], 0 offen
    buffer_load_dword v127, v126, s[28:31], 0 offen
L_x0join_16:
    s_nop 1
    v_mov_b32 v42, 159744
    ds_read_b32 v43, v42 offset:4
    s_waitcnt lgkmcnt(0)
    v_readfirstlane_b32 s47, v43
    s_waitcnt vmcnt(32)
    s_waitcnt vmcnt(15)
    s_mov_b64 exec, s[76:77]
    ds_write_b128 v120, v[122:125] offset:0
    s_mov_b64 exec, -1
    s_waitcnt lgkmcnt(0)
    s_barrier
    s_cmp_lg_u32 s48, 0
    s_cbranch_scc1 L_fl_18
    s_waitcnt vmcnt(20)
    s_cmp_lt_u32 s2, 86
    s_cbranch_scc1 L_spA_19
    s_cmp_lt_u32 s2, 204
    s_cbranch_scc1 L_spB_20
    s_branch L_spE_21
L_spA_19:
    v_mov_b32 v64, 0
    v_mov_b32 v65, 0
    v_mov_b32 v66, 0
    v_mov_b32 v67, 0
    v_mov_b32 v68, 0
    v_mov_b32 v69, 0
    v_mov_b32 v70, 0
    v_mov_b32 v71, 0
    v_mov_b32 v72, 0
    v_mov_b32 v73, 0
    v_mov_b32 v74, 0
    v_mov_b32 v75, 0
    v_mov_b32 v76, 0
    v_mov_b32 v77, 0
    v_mov_b32 v78, 0
    v_mov_b32 v79, 0
    v_mov_b32 v80, 0x3f803f80
    v_mov_b32 v81, 0x3f803f80
    v_mov_b32 v82, 0x3f803f80
    v_mov_b32 v83, 0x3f803f80
    ds_read_b64_tr_b16 v[84:85], v25 offset:0
    ds_read_b64_tr_b16 v[86:87], v25 offset:1024
    ds_read_b64_tr_b16 v[88:89], v25 offset:512
    ds_read_b64_tr_b16 v[90:91], v25 offset:1536
    ds_read_b64_tr_b16 v[92:93], v25 offset:8192
    ds_read_b64_tr_b16 v[94:95], v25 offset:9216
    ds_read_b64_tr_b16 v[96:97], v25 offset:8704
    ds_read_b64_tr_b16 v[98:99], v25 offset:9728
    ds_read_b64_tr_b16 v[100:101], v25 offset:16384
    ds_read_b64_tr_b16 v[102:103], v25 offset:17408
    ds_read_b64_tr_b16 v[104:105], v25 offset:16896
    ds_read_b64_tr_b16 v[106:107], v25 offset:17920
    ds_read_b64_tr_b16 v[108:109], v25 offset:24576
    ds_read_b64_tr_b16 v[110:111], v25 offset:25600
    ds_read_b64_tr_b16 v[112:113], v25 offset:25088
    ds_read_b64_tr_b16 v[114:115], v25 offset:26112
    s_waitcnt lgkmcnt(0)
    v_mfma_f32_32x32x16_bf16 v[64:79], v[84:87], v[80:83], v[64:79]
    s_add_u32 s96, s67, 0
    buffer_store_dwordx4 v[84:87], v1, s[8:11], s96 offen sc1
    v_mfma_f32_32x32x16_bf16 v[64:79], v[88:91], v[80:83], v[64:79]
    s_add_u32 s96, s67, 2048
    buffer_store_dwordx4 v[88:91], v1, s[8:11], s96 offen sc1
    v_mfma_f32_32x32x16_bf16 v[64:79], v[92:95], v[80:83], v[64:79]
    s_add_u32 s96, s67, 16384
    buffer_store_dwordx4 v[92:95], v1, s[8:11], s96 offen sc1
    v_mfma_f32_32x32x16_bf16 v[64:79], v[96:99], v[80:83], v[64:79]
    s_add_u32 s96, s67, 18432
    buffer_store_dwordx4 v[96:99], v1, s[8:11], s96 offen sc1
    v_mfma_f32_32x32x16_bf16 v[64:79], v[100:103], v[80:83], v[64:79]
    s_add_u32 s96, s67, 32768
    buffer_store_dwordx4 v[100:103], v1, s[8:11], s96 offen sc1
    v_mfma_f32_32x32x16_bf16 v[64:79], v[104:107], v[80:83], v[64:79]
    s_add_u32 s96, s67, 34816
    buffer_store_dwordx4 v[104:107], v1, s[8:11], s96 offen sc1
    v_mfma_f32_32x32x16_bf16 v[64:79], v[108:111], v[80:83], v[64:79]
    s_add_u32 s96, s67, 49152
    buffer_store_dwordx4 v[108:111], v1, s[8:11], s96 offen sc1
    v_mfma_f32_32x32x16_bf16 v[64:79], v[112:115], v[80:83], v[64:79]
    s_add_u32 s96, s67, 51200
    buffer_store_dwordx4 v[112:115], v1, s[8:11], s96 offen sc1
    s_lshl_b32 s54, s2, 2
    s_add_u32 s54, s54, s46
    s_lshl_b32 s54, s54, 7
    s_add_u32 s54, s54, 29294592
    v_lshrrev_b32 v24, 5, v15
    v_lshlrev_b32 v24, 6, v24
    s_mov_b32 s68, 1
    s_mov_b32 s69, 1
    s_mov_b64 exec, s[68:69]
    s_nop 0
    buffer_store_dwordx4 v[64:67], v24, s[8:11], s54 offen offset:0 sc1
    buffer_store_dwordx4 v[68:71], v24, s[8:11], s54 offen offset:16 sc1
    buffer_store_dwordx4 v[72:75], v24, s[8:11], s54 offen offset:32 sc1
    buffer_store_dwordx4 v[76:79], v24, s[8:11], s54 offen offset:48 sc1
    s_mov_b64 exec, -1
    s_branch L_spE_21
L_spB_20:
    ds_read_b64_tr_b16 v[84:85], v60
    ds_read_b64_tr_b16 v[86:87], v61
    ds_read_b64_tr_b16 v[88:89], v62
    ds_read_b64_tr_b16 v[90:91], v63
    ds_read_b64_tr_b16 v[92:93], v64
    ds_read_b64_tr_b16 v[94:95], v65
    ds_read_b64_tr_b16 v[96:97], v66
    ds_read_b64_tr_b16 v[98:99], v67
    s_waitcnt lgkmcnt(0)
    buffer_store_dwordx4 v[84:87], v1, s[8:11], s67 offen offset:0 sc1
    buffer_store_dwordx4 v[88:91], v1, s[8:11], s67 offen offset:1024 sc1
    buffer_store_dwordx4 v[92:95], v1, s[8:11], s67 offen offset:2048 sc1
    buffer_store_dwordx4 v[96:99], v1, s[8:11], s67 offen offset:3072 sc1
L_spE_21:
    s_waitcnt lgkmcnt(0)
    s_nop 3
    s_and_b32 s53, s44, 3
    s_lshl_b32 s53, s53, 2
    s_add_u32 s53, s53, s46
    s_mul_i32 s53, s53, 96
    s_lshl_b32 s54, s45, 7
    v_and_b32 v116, 63, v15
    v_add_u32 v116, s53, v116
    v_mul_u32_u24 v117, 21846, v116
    v_lshrrev_b32 v117, 16, v117
    v_mul_u32_u24 v118, 3, v117
    v_sub_u32 v116, v116, v118
    v_lshlrev_b32 v116, 10, v116
    v_mul_u32_u24 v117, 3072, v117
    v_add_u32 v116, v116, v117
    buffer_load_dword v127, v116, s[16:19], s54 offen
    v_and_b32 v116, 31, v15
    v_add_u32 v116, s53, v116
    v_add_u32 v116, 64, v116
    v_mul_u32_u24 v117, 21846, v116
    v_lshrrev_b32 v117, 16, v117
    v_mul_u32_u24 v118, 3, v117
    v_sub_u32 v116, v116, v118
    v_lshlrev_b32 v116, 10, v116
    v_mul_u32_u24 v117, 3072, v117
    v_add_u32 v116, v116, v117
    buffer_load_dword v127, v116, s[16:19], s54 offen
L_fl_18:
    s_nop 1
    s_barrier
    s_add_u32 m0, s59, 0
    s_mov_b32 s96, 589824
    buffer_load_dwordx4 v10, s[16:19], s96 offen lds
    buffer_load_dwordx4 v10, s[16:19], s96 offen offset:1024 lds
    buffer_load_dwordx4 v10, s[16:19], s96 offen offset:2048 lds
    s_add_u32 m0, s59, 12288
    s_mov_b32 s96, 688128
    buffer_load_dwordx4 v10, s[16:19], s96 offen lds
    buffer_load_dwordx4 v10, s[16:19], s96 offen offset:1024 lds
    buffer_load_dwordx4 v10, s[16:19], s96 offen offset:2048 lds
    s_cmp_lg_u32 s48, 0
    s_cbranch_scc1 L_fl_22
    s_waitcnt vmcnt(6)
    s_lshl_b32 s55, s2, 2
    s_add_u32 s55, s55, s46
    s_lshl_b32 s55, s55, 2
    s_add_u32 s54, s55, 26312704
    v_mov_b32 v44, s47
    s_mov_b64 exec, 1
    buffer_store_dword v44, v126, s[8:11], s54 offen sc1
    s_mov_b64 exec, -1
L_fl_22:
    s_nop 1
    s_waitcnt vmcnt(16)
    s_mov_b64 exec, s[76:77]
    ds_write_b128 v120, v[122:125] offset:20480
    s_mov_b64 exec, -1
    s_waitcnt lgkmcnt(0)
    s_barrier
    s_add_u32 m0, s59, 24576
    s_mov_b32 s96, 786432
    buffer_load_dwordx4 v10, s[16:19], s96 offen lds
    buffer_load_dwordx4 v10, s[16:19], s96 offen offset:1024 lds
    buffer_load_dwordx4 v10, s[16:19], s96 offen offset:2048 lds
    s_add_u32 m0, s59, 36864
    s_mov_b32 s96, 884736
    buffer_load_dwordx4 v10, s[16:19], s96 offen lds
    buffer_load_dwordx4 v10, s[16:19], s96 offen offset:1024 lds
    buffer_load_dwordx4 v10, s[16:19], s96 offen offset:2048 lds
    s_cmp_lg_u32 s48, 0
    s_cbranch_scc1 L_fl_23
    s_cmp_lt_u32 s46, 2
    s_cbranch_scc1 L_fl_23
    v_cmp_gt_u32 vcc, 16, v15
    s_nop 1
    v_cndmask_b32 v130, v130, v122, vcc
    v_cndmask_b32 v131, v131, v122, vcc
    v_cndmask_b32 v132, v132, v122, vcc
    v_cndmask_b32 v133, v133, v122, vcc
    ds_write_b64 v119, v[130:131] offset:0
    ds_write_b64 v119, v[132:133] offset:256
    ds_write_b64 v119, v[134:135] offset:64
    ds_write_b64 v119, v[136:137] offset:320
    ds_write_b64 v119, v[138:139] offset:128
    ds_write_b64 v119, v[140:141] offset:384
    ds_write_b64 v119, v[142:143] offset:192
    ds_write_b64 v119, v[144:145] offset:448
    ds_write_b64 v119, v[146:147] offset:1024
    ds_write_b64 v119, v[148:149] offset:1280
    ds_write_b64 v119, v[150:151] offset:1088
    ds_write_b64 v119, v[152:153] offset:1344
    ds_write_b64 v119, v[154:155] offset:1152
    ds_write_b64 v119, v[156:157] offset:1408
    ds_write_b64 v119, v[158:159] offset:1216
    ds_write_b64 v119, v[160:161] offset:1472
    ds_write_b64 v119, v[162:163] offset:2048
    ds_write_b64 v119, v[164:165] offset:2304
    ds_write_b64 v119, v[166:167] offset:2112
    ds_write_b64 v119, v[168:169] offset:2368
    ds_write_b64 v119, v[170:171] offset:2176
    ds_write_b64 v119, v[172:173] offset:2432
    ds_write_b64 v119, v[174:175] offset:2240
    ds_write_b64 v119, v[176:177] offset:2496
    ds_write_b64 v119, v[178:179] offset:3072
    ds_write_b64 v119, v[180:181] offset:3328
    ds_write_b64 v119, v[182:183] offset:3136
    ds_write_b64 v119, v[184:185] offset:3392
    ds_write_b64 v119, v[186:187] offset:3200
    ds_write_b64 v119, v[188:189] offset:3456
    ds_write_b64 v119, v[190:191] offset:3264
    ds_write_b64 v119, v[192:193] offset:3520
    ds_write_b64 v119, v[194:195] offset:4096
    ds_write_b64 v119, v[196:197] offset:4352
    ds_write_b64 v119, v[198:199] offset:4160
    ds_write_b64 v119, v[200:201] offset:4416
    ds_write_b64 v119, v[202:203] offset:4224
    ds_write_b64 v119, v[204:205] offset:4480
    ds_write_b64 v119, v[206:207] offset:4288
    ds_write_b64 v119, v[208:209] offset:4544
    s_waitcnt lgkmcnt(0)
L_fl_23:
    s_nop 1
    s_waitcnt vmcnt(6)
    s_barrier
    s_add_u32 m0, s59, 49152
    s_mov_b32 s96, 983040
    buffer_load_dwordx4 v10, s[16:19], s96 offen lds
    buffer_load_dwordx4 v10, s[16:19], s96 offen offset:1024 lds
    buffer_load_dwordx4 v10, s[16:19], s96 offen offset:2048 lds
    s_add_u32 m0, s59, 61440
    s_mov_b32 s96, 1081344
    buffer_load_dwordx4 v10, s[16:19], s96 offen lds
    buffer_load_dwordx4 v10, s[16:19], s96 offen offset:1024 lds
    buffer_load_dwordx4 v10, s[16:19], s96 offen offset:2048 lds
    s_cmp_lg_u32 s48, 0
    s_cbranch_scc1 L_fl_24
    s_cmp_gt_u32 s46, 1
    s_cbranch_scc1 L_fl_24
    s_lshl_b32 s54, s44, 5
    v_and_b32 v50, 31, v15
    v_add_u32 v50, s54, v50
    s_sub_u32 s55, s54, 32
    s_cmp_eq_u32 s44, 0
    s_cselect_b32 s55, s54, s55
    v_and_b32 v52, 7, v15
    v_lshlrev_b32 v52, 2, v52
    v_add_u32 v52, 3, v52
    v_add_u32 v52, s55, v52
    v_cmp_gt_u32 vcc, 32, v15
    s_nop 1
    v_cndmask_b32 v50, v52, v50, vcc
    v_lshlrev_b32 v50, 2, v50
    s_lshr_b32 s54, s44, 2
    s_lshl_b32 s54, s54, 7
    v_and_b32 v54, 31, v15
    v_lshlrev_b32 v54, 2, v54
    v_add_u32 v54, s54, v54
    v_lshlrev_b32 v54, 2, v54
    s_mov_b32 s54, 26296320
    buffer_load_dword v51, v50, s[8:11], s54 offen sc1
    buffer_load_dword v55, v54, s[8:11], s54 offen sc1
L_fl_24:
    s_nop 1
    s_waitcnt vmcnt(6)
    s_mov_b64 exec, s[76:77]
    ds_write_b128 v120, v[122:125] offset:40960
    s_mov_b64 exec, -1
    s_waitcnt lgkmcnt(0)
    s_barrier
    s_add_u32 m0, s59, 0
    s_mov_b32 s96, 1179648
    buffer_load_dwordx4 v10, s[16:19], s96 offen lds
    buffer_load_dwordx4 v10, s[16:19], s96 offen offset:1024 lds
    buffer_load_dwordx4 v10, s[16:19], s96 offen offset:2048 lds
    s_add_u32 m0, s59, 12288
    s_mov_b32 s96, 1277952
    buffer_load_dwordx4 v10, s[16:19], s96 offen lds
    buffer_load_dwordx4 v10, s[16:19], s96 offen offset:1024 lds
    buffer_load_dwordx4 v10, s[16:19], s96 offen offset:2048 lds
    s_cmp_lg_u32 s48, 0
    s_cbranch_scc1 L_fl_25
    s_cmp_gt_u32 s46, 1
    s_cbranch_scc1 L_fl_25
    s_waitcnt vmcnt(6)
    s_mov_b32 s83, 0
L_pchk_26:
    v_and_b32 v52, -16, v51
    v_xor_b32 v52, s47, v52
    v_and_b32 v53, -16, v55
    v_xor_b32 v53, s47, v53
    v_or_b32 v52, v52, v53
    v_cmp_ne_u32 vcc, 0, v52
    s_nop 3
    s_cmp_eq_u64 vcc, 0
    s_cbranch_scc1 L_pok_27
    s_add_u32 s83, s83, 1
    s_cmp_ge_u32 s83, 200000
    s_cbranch_scc1 L_pok_27
    s_mov_b32 s54, 26296320
    buffer_load_dword v51, v50, s[8:11], s54 offen sc1
    buffer_load_dword v55, v54, s[8:11], s54 offen sc1
    s_waitcnt vmcnt(0)
    s_branch L_pchk_26
L_pok_27:
    s_cmp_gt_u32 s46, 1
    s_cbranch_scc1 L_nostat0_29
    buffer_load_dwordx4 v[20:23], v40, s[8:11], s71 offen offset:0 sc1
    buffer_load_dwordx4 v[24:27], v40, s[8:11], s71 offen offset:16 sc1
    buffer_load_dwordx4 v[28:31], v40, s[8:11], s71 offen offset:32 sc1
    buffer_load_dwordx4 v[32:35], v40, s[8:11], s71 offen offset:48 sc1
L_nostat0_29:
    s_cmp_lg_u32 s46, 0
    s_cbranch_scc1 L_nl0_28
    v_and_b32 v52, 15, v55
    v_cmp_ne_u32 vcc, s100, v52
    s_cmp_eq_u32 vcc_lo, 0
    s_cselect_b32 s55, 1, 0
    v_mov_b32 v52, 159744
    v_mov_b32 v53, s55
    ds_write_b32 v52, v53
    s_waitcnt lgkmcnt(0)
L_nl0_28:
L_fl_25:
    s_nop 1
    s_cmp_lg_u32 s48, 0
    s_cbranch_scc1 L_fl_30
    s_lshl_b32 s54, s45, 4
    s_add_u32 s54, s54, 344
    v_add_u32 v45, s54, v15
    s_lshl_b32 s54, s80, 3
    s_sub_u32 s54, s54, 16
    v_min_u32 v47, 39, v15
    v_add_u32 v47, s54, v47
    v_cmp_lt_u32 vcc, 15, v15
    s_nop 1
    v_cndmask_b32 v45, v45, v47, vcc
    v_lshlrev_b32 v45, 2, v45
    s_mul_i32 s54, s45, 43
    s_add_u32 s54, s54, 472
    v_min_u32 v115, 42, v15
    v_add_u32 v115, s54, v115
    v_lshlrev_b32 v115, 2, v115
    s_mov_b32 s54, 26312704
    buffer_load_dword v46, v45, s[8:11], s54 offen sc1
L_fl_30:
    s_nop 1
    s_waitcnt vmcnt(6)
    s_barrier
    s_add_u32 m0, s59, 24576
    s_mov_b32 s96, 1376256
    buffer_load_dwordx4 v10, s[16:19], s96 offen lds
    buffer_load_dwordx4 v10, s[16:19], s96 offen offset:1024 lds
    buffer_load_dwordx4 v10, s[16:19], s96 offen offset:2048 lds
    s_add_u32 m0, s59, 36864
    s_mov_b32 s96, 1474560
    buffer_load_dwordx4 v10, s[16:19], s96 offen lds
    buffer_load_dwordx4 v10, s[16:19], s96 offen offset:1024 lds
    buffer_load_dwordx4 v10, s[16:19], s96 offen offset:2048 lds
    s_cmp_lg_u32 s48, 0
    s_cbranch_scc1 L_fl_31
    s_waitcnt vmcnt(6)
    s_mov_b32 s83, 0
L_pchk_32:
    v_cmp_ne_u32 vcc, s47, v46
    s_nop 3
    s_cmp_eq_u64 vcc, 0
    s_cbranch_scc1 L_pok_33
    s_add_u32 s83, s83, 1
    s_cmp_ge_u32 s83, 200000
    s_cbranch_scc1 L_pok_33
    s_mov_b32 s54, 26312704
    buffer_load_dword v46, v45, s[8:11], s54 offen sc1
    s_waitcnt vmcnt(0)
    s_branch L_pchk_32
L_pok_33:
    s_cmp_lg_u32 s46, 0
    s_cbranch_scc1 L_nl0_34
    v_lshrrev_b32 v52, 5, v15
    v_lshlrev_b32 v52, 9, v52
    v_and_b32 v53, 31, v15
    v_lshl_add_u32 v52, v53, 2, v52
    s_lshl_b32 s54, s80, 10
    s_add_u32 s54, s54, 29294592
    buffer_load_dword v56, v52, s[8:11], s54 offen offset:0 sc1
    buffer_load_dword v57, v52, s[8:11], s54 offen offset:128 sc1
    buffer_load_dword v58, v52, s[8:11], s54 offen offset:256 sc1
    buffer_load_dword v59, v52, s[8:11], s54 offen offset:384 sc1
    buffer_load_dword v60, v52, s[8:11], s54 offen offset:1024 sc1
    buffer_load_dword v61, v52, s[8:11], s54 offen offset:1152 sc1
    buffer_load_dword v62, v52, s[8:11], s54 offen offset:1280 sc1
    buffer_load_dword v63, v52, s[8:11], s54 offen offset:1408 sc1
    buffer_load_dword v64, v52, s[8:11], s54 offen offset:2048 sc1
    buffer_load_dword v65, v52, s[8:11], s54 offen offset:2176 sc1
    buffer_load_dword v66, v52, s[8:11], s54 offen offset:2304 sc1
    buffer_load_dword v67, v52, s[8:11], s54 offen offset:2432 sc1
L_nl0_34:
L_fl_31:
    s_nop 1
    s_waitcnt vmcnt(6)
    s_mov_b64 exec, s[76:77]
    ds_write_b128 v120, v[122:125] offset:61440
    s_mov_b64 exec, -1
    s_waitcnt lgkmcnt(0)
    s_barrier
    s_add_u32 m0, s60, 49152
    s_add_u32 s96, s64, 0
    buffer_load_dwordx4 v16, s[8:11], s96 offen lds
    s_add_u32 m0, s60, 53248
    s_add_u32 s96, s64, 4096
    buffer_load_dwordx4 v16, s[8:11], s96 offen lds
    s_add_u32 m0, s60, 57344
    s_add_u32 s96, s64, 8192
    buffer_load_dwordx4 v16, s[8:11], s96 offen lds
    s_add_u32 m0, s60, 61440
    s_add_u32 s96, s64, 12288
    buffer_load_dwordx4 v16, s[8:11], s96 offen lds
    s_add_u32 m0, s60, 65536
    s_add_u32 s96, s64, 16384
    buffer_load_dwordx4 v16, s[8:11], s96 offen lds
    s_add_u32 m0, s60, 69632
    s_add_u32 s96, s64, 20480
    buffer_load_dwordx4 v16, s[8:11], s96 offen lds
    s_cmp_gt_u32 s46, 1
    s_cbranch_scc1 L_nostat2_35
    v_pk_add_f32 v[20:21], v[20:21], v[22:23]
    v_pk_add_f32 v[24:25], v[24:25], v[26:27]
    v_pk_add_f32 v[28:29], v[28:29], v[30:31]
    v_pk_add_f32 v[32:33], v[32:33], v[34:35]
    v_pk_add_f32 v[20:21], v[20:21], v[24:25]
    v_pk_add_f32 v[28:29], v[28:29], v[32:33]
    v_pk_add_f32 v[20:21], v[20:21], v[28:29]
    v_mul_f32 v20, 0xbb000000, v20
    v_mul_f32 v21, 0x3b000000, v21
    v_fma_f32 v21, -v20, v20, v21
    v_max_f32 v21, 0, v21
    v_add_f32 v21, 0x3727c5ac, v21
    v_rsq_f32 v21, v21
    ds_write_b32 v41, v20
    ds_write_b32 v41, v21 offset:512
    s_waitcnt lgkmcnt(0)
L_nostat2_35:
    s_nop 1
    s_waitcnt vmcnt(6)
    s_barrier
    s_add_u32 m0, s60, 0
    s_add_u32 s96, s64, 24576
    buffer_load_dwordx4 v16, s[8:11], s96 offen lds
    s_add_u32 m0, s60, 4096
    s_add_u32 s96, s64, 28672
    buffer_load_dwordx4 v16, s[8:11], s96 offen lds
    s_add_u32 m0, s60, 8192
    s_add_u32 s96, s64, 32768
    buffer_load_dwordx4 v16, s[8:11], s96 offen lds
    s_add_u32 m0, s60, 12288
    s_add_u32 s96, s64, 36864
    buffer_load_dwordx4 v16, s[8:11], s96 offen lds
    s_add_u32 m0, s60, 16384
    s_add_u32 s96, s64, 40960
    buffer_load_dwordx4 v16, s[8:11], s96 offen lds
    s_add_u32 m0, s60, 20480
    s_add_u32 s96, s64, 45056
    buffer_load_dwordx4 v16, s[8:11], s96 offen lds
    s_cmp_lg_u32 s48, 0
    s_cbranch_scc1 L_fl_36
    s_cmp_lg_u32 s46, 0
    s_cbranch_scc1 L_fl_36
    v_lshlrev_b32 v53, 2, v15
    v_add_u32 v53, 156672, v53
    v_add_f32 v56, v56, v57
    v_add_f32 v58, v58, v59
    v_add_f32 v56, v56, v58
    ds_write_b32 v53, v56 offset:0
    v_add_f32 v60, v60, v61
    v_add_f32 v62, v62, v63
    v_add_f32 v60, v60, v62
    ds_write_b32 v53, v60 offset:256
    v_add_f32 v64, v64, v65
    v_add_f32 v66, v66, v67
    v_add_f32 v64, v64, v66
    ds_write_b32 v53, v64 offset:512
    s_waitcnt lgkmcnt(0)
L_fl_36:
    s_nop 1
    s_barrier
    s_add_u32 m0, s60, 24576
    s_add_u32 s96, s64, 49152
    buffer_load_dwordx4 v16, s[8:11], s96 offen lds
    s_add_u32 m0, s60, 28672
    s_add_u32 s96, s64, 53248
    buffer_load_dwordx4 v16, s[8:11], s96 offen lds
    s_add_u32 m0, s60, 32768
    s_add_u32 s96, s64, 57344
    buffer_load_dwordx4 v16, s[8:11], s96 offen lds
    s_add_u32 m0, s60, 36864
    s_add_u32 s96, s64, 61440
    buffer_load_dwordx4 v16, s[8:11], s96 offen lds
    s_add_u32 m0, s60, 73728
    s_add_u32 s96, s65, 0
    buffer_load_dwordx4 v16, s[8:11], s96 offen lds
    s_add_u32 m0, s60, 77824
    s_add_u32 s96, s65, 65536
    buffer_load_dwordx4 v16, s[8:11], s96 offen lds
    s_add_u32 m0, s60, 81920
    s_add_u32 s96, s65, 131072
    buffer_load_dwordx4 v16, s[8:11], s96 offen lds
    s_add_u32 m0, s60, 86016
    s_add_u32 s96, s65, 4096
    buffer_load_dwordx4 v16, s[8:11], s96 offen lds
    s_add_u32 m0, s60, 90112
    s_add_u32 s96, s65, 69632
    buffer_load_dwordx4 v16, s[8:11], s96 offen lds
    s_add_u32 m0, s60, 94208
    s_add_u32 s96, s65, 135168
    buffer_load_dwordx4 v16, s[8:11], s96 offen lds
    s_add_u32 m0, s60, 98304
    s_add_u32 s96, s65, 8192
    buffer_load_dwordx4 v16, s[8:11], s96 offen lds
    s_add_u32 m0, s60, 102400
    s_add_u32 s96, s65, 73728
    buffer_load_dwordx4 v16, s[8:11], s96 offen lds
    s_add_u32 m0, s60, 106496
    s_add_u32 s96, s65, 139264
    buffer_load_dwordx4 v16, s[8:11], s96 offen lds
    s_add_u32 m0, s60, 110592
    s_add_u32 s96, s65, 12288
    buffer_load_dwordx4 v16, s[8:11], s96 offen lds
    s_add_u32 m0, s60, 114688
    s_add_u32 s96, s65, 77824
    buffer_load_dwordx4 v16, s[8:11], s96 offen lds
    s_add_u32 m0, s60, 118784
    s_add_u32 s96, s65, 143360
    buffer_load_dwordx4 v16, s[8:11], s96 offen lds
    s_barrier
    s_waitcnt vmcnt(12)
    s_barrier
    s_barrier
    s_add_u32 m0, s60, 122880
    s_add_u32 s96, s65, 16384
    buffer_load_dwordx4 v16, s[8:11], s96 offen lds
    s_add_u32 m0, s60, 126976
    s_add_u32 s96, s65, 81920
    buffer_load_dwordx4 v16, s[8:11], s96 offen lds
    s_add_u32 m0, s60, 131072
    s_add_u32 s96, s65, 147456
    buffer_load_dwordx4 v16, s[8:11], s96 offen lds
    s_add_u32 m0, s60, 135168
    s_add_u32 s96, s65, 20480
    buffer_load_dwordx4 v16, s[8:11], s96 offen lds
    s_add_u32 m0, s60, 139264
    s_add_u32 s96, s65, 86016
    buffer_load_dwordx4 v16, s[8:11], s96 offen lds
    s_add_u32 m0, s60, 143360
    s_add_u32 s96, s65, 151552
    buffer_load_dwordx4 v16, s[8:11], s96 offen lds
    s_barrier
    s_barrier
    s_add_u32 m0, s60, 0
    s_add_u32 s96, s65, 24576
    buffer_load_dwordx4 v16, s[8:11], s96 offen lds
    s_add_u32 m0, s60, 4096
    s_add_u32 s96, s65, 90112
    buffer_load_dwordx4 v16, s[8:11], s96 offen lds
    s_add_u32 m0, s60, 8192
    s_add_u32 s96, s65, 155648
    buffer_load_dwordx4 v16, s[8:11], s96 offen lds
    s_add_u32 m0, s60, 12288
    s_add_u32 s96, s65, 28672
    buffer_load_dwordx4 v16, s[8:11], s96 offen lds
    s_add_u32 m0, s60, 16384
    s_add_u32 s96, s65, 94208
    buffer_load_dwordx4 v16, s[8:11], s96 offen lds
    s_add_u32 m0, s60, 20480
    s_add_u32 s96, s65, 159744
    buffer_load_dwordx4 v16, s[8:11], s96 offen lds
    s_add_u32 m0, s60, 24576
    s_add_u32 s96, s65, 32768
    buffer_load_dwordx4 v16, s[8:11], s96 offen lds
    s_add_u32 m0, s60, 28672
    s_add_u32 s96, s65, 98304
    buffer_load_dwordx4 v16, s[8:11], s96 offen lds
    s_add_u32 m0, s60, 32768
    s_add_u32 s96, s65, 163840
    buffer_load_dwordx4 v16, s[8:11], s96 offen lds
    s_waitcnt vmcnt(21)
    s_barrier
    s_waitcnt vmcnt(15)
    s_barrier
    s_add_u32 m0, s60, 36864
    s_add_u32 s96, s65, 36864
    buffer_load_dwordx4 v16, s[8:11], s96 offen lds
    s_add_u32 m0, s60, 40960
    s_add_u32 s96, s65, 102400
    buffer_load_dwordx4 v16, s[8:11], s96 offen lds
    s_add_u32 m0, s60, 45056
    s_add_u32 s96, s65, 167936
    buffer_load_dwordx4 v16, s[8:11], s96 offen lds
    s_add_u32 m0, s60, 49152
    s_add_u32 s96, s65, 40960
    buffer_load_dwordx4 v16, s[8:11], s96 offen lds
    s_add_u32 m0, s60, 53248
    s_add_u32 s96, s65, 106496
    buffer_load_dwordx4 v16, s[8:11], s96 offen lds
    s_add_u32 m0, s60, 57344
    s_add_u32 s96, s65, 172032
    buffer_load_dwordx4 v16, s[8:11], s96 offen lds
    s_add_u32 m0, s60, 61440
    s_add_u32 s96, s65, 45056
    buffer_load_dwordx4 v16, s[8:11], s96 offen lds
    s_add_u32 m0, s60, 65536
    s_add_u32 s96, s65, 110592
    buffer_load_dwordx4 v16, s[8:11], s96 offen lds
    s_add_u32 m0, s60, 69632
    s_add_u32 s96, s65, 176128
    buffer_load_dwordx4 v16, s[8:11], s96 offen lds
    s_cmp_lg_u32 s46, 3
    s_cbranch_scc1 L_ntch_53
    s_lshr_b32 s54, s44, 1
    s_mul_i32 s54, s54, 344
    s_add_u32 s54, s54, s80
    s_lshl_b32 s54, s54, 10
    s_add_u32 s54, s54, s50
    s_add_u32 s54, s54, 12582912
    v_add_u32 v68, 0, v15
    v_mul_u32_u24 v69, 43691, v68
    v_lshrrev_b32 v69, 20, v69
    v_mul_u32_u24 v70, 24, v69
    v_sub_u32 v68, v68, v70
    v_lshlrev_b32 v68, 7, v68
    v_mul_u32_u24 v69, 44032, v69
    v_add_u32 v68, v68, v69
    buffer_load_dword v70, v68, s[8:11], s54 offen
    v_add_u32 v68, 64, v15
    v_mul_u32_u24 v69, 43691, v68
    v_lshrrev_b32 v69, 20, v69
    v_mul_u32_u24 v71, 24, v69
    v_sub_u32 v68, v68, v71
    v_lshlrev_b32 v68, 7, v68
    v_mul_u32_u24 v69, 44032, v69
    v_add_u32 v68, v68, v69
    buffer_load_dword v71, v68, s[8:11], s54 offen
    v_add_u32 v68, 128, v15
    v_mul_u32_u24 v69, 43691, v68
    v_lshrrev_b32 v69, 20, v69
    v_mul_u32_u24 v72, 24, v69
    v_sub_u32 v68, v68, v72
    v_lshlrev_b32 v68, 7, v68
    v_mul_u32_u24 v69, 44032, v69
    v_add_u32 v68, v68, v69
    buffer_load_dword v72, v68, s[8:11], s54 offen
L_ntch_53:
    s_nop 1
    s_waitcnt vmcnt(18)
    s_barrier
    s_add_u32 m0, s60, 73728
    s_add_u32 s96, s65, 49152
    buffer_load_dwordx4 v16, s[8:11], s96 offen lds
    s_add_u32 m0, s60, 77824
    s_add_u32 s96, s65, 114688
    buffer_load_dwordx4 v16, s[8:11], s96 offen lds
    s_add_u32 m0, s60, 81920
    s_add_u32 s96, s65, 180224
    buffer_load_dwordx4 v16, s[8:11], s96 offen lds
    s_add_u32 m0, s60, 86016
    s_add_u32 s96, s65, 53248
    buffer_load_dwordx4 v16, s[8:11], s96 offen lds
    s_add_u32 m0, s60, 90112
    s_add_u32 s96, s65, 118784
    buffer_load_dwordx4 v16, s[8:11], s96 offen lds
    s_add_u32 m0, s60, 94208
    s_add_u32 s96, s65, 184320
    buffer_load_dwordx4 v16, s[8:11], s96 offen lds
    s_cmp_lg_u32 s48, 0
    s_cbranch_scc1 L_w4ok_54
    s_mov_b32 s54, 26312704
    buffer_load_dword v46, v115, s[8:11], s54 offen sc1
L_w4ok_54:
    s_nop 1
    s_waitcnt vmcnt(18)
    s_barrier
    s_add_u32 m0, s60, 98304
    s_add_u32 s96, s65, 57344
    buffer_load_dwordx4 v16, s[8:11], s96 offen lds
    s_add_u32 m0, s60, 102400
    s_add_u32 s96, s65, 122880
    buffer_load_dwordx4 v16, s[8:11], s96 offen lds
    s_add_u32 m0, s60, 106496
    s_add_u32 s96, s65, 188416
    buffer_load_dwordx4 v16, s[8:11], s96 offen lds
    s_add_u32 m0, s60, 110592
    s_add_u32 s96, s65, 61440
    buffer_load_dwordx4 v16, s[8:11], s96 offen lds
    s_add_u32 m0, s60, 114688
    s_add_u32 s96, s65, 126976
    buffer_load_dwordx4 v16, s[8:11], s96 offen lds
    s_add_u32 m0, s60, 118784
    s_add_u32 s96, s65, 192512
    buffer_load_dwordx4 v16, s[8:11], s96 offen lds
    s_cmp_lg_u32 s46, 3
    s_cbranch_scc1 L_ntch_55
    v_lshrrev_b32 v68, 4, v15
    v_lshlrev_b32 v68, 14, v68
    v_and_b32 v74, 15, v15
    v_lshl_add_u32 v68, v74, 7, v68
    s_lshl_b32 s54, s44, 16
    s_lshl_b32 s55, s45, 11
    s_add_u32 s54, s54, s55
    s_add_u32 s54, s54, s49
    s_add_u32 s54, s54, 2097152
    buffer_load_dword v74, v68, s[8:11], s54 offen
    v_and_b32 v68, 31, v15
    v_lshlrev_b32 v68, 7, v68
    s_lshl_b32 s54, s44, 12
    s_add_u32 s54, s54, s51
    s_add_u32 s54, s54, 25296896
    buffer_load_dword v75, v68, s[8:11], s54 offen
L_ntch_55:
    s_nop 1
    s_waitcnt vmcnt(18)
    s_barrier
    s_cmp_lg_u32 s48, 0
    s_cbranch_scc1 L_w4ok_56
    s_waitcnt vmcnt(6)
    s_mov_b32 s83, 0
L_w4p_57:
    v_cmp_ne_u32 vcc, s47, v46
    s_nop 3
    s_cmp_eq_u64 vcc, 0
    s_cbranch_scc1 L_w4ok_56
    s_add_u32 s83, s83, 1
    s_cmp_ge_u32 s83, 200000
    s_cbranch_scc1 L_w4ok_56
    s_mov_b32 s54, 26312704
    buffer_load_dword v46, v115, s[8:11], s54 offen sc1
    s_waitcnt vmcnt(0)
    s_branch L_w4p_57
L_w4ok_56:
    s_nop 1
    s_add_u32 m0, s60, 147456
    s_add_u32 s96, s66, 0
    buffer_load_dwordx4 v16, s[8:11], s96 offen lds
    s_add_u32 m0, s60, 151552
    s_add_u32 s96, s66, 4096
    buffer_load_dwordx4 v16, s[8:11], s96 offen lds
    s_add_u32 m0, s60, 122880
    s_add_u32 s96, s66, 8192
    buffer_load_dwordx4 v16, s[8:11], s96 offen lds
    s_add_u32 m0, s60, 126976
    s_add_u32 s96, s66, 12288
    buffer_load_dwordx4 v16, s[8:11], s96 offen lds
    s_add_u32 m0, s60, 131072
    s_add_u32 s96, s66, 16384
    buffer_load_dwordx4 v16, s[8:11], s96 offen lds
    s_add_u32 m0, s60, 135168
    s_add_u32 s96, s66, 20480
    buffer_load_dwordx4 v16, s[8:11], s96 offen lds
    s_add_u32 m0, s60, 139264
    s_add_u32 s96, s66, 24576
    buffer_load_dwordx4 v16, s[8:11], s96 offen lds
    s_add_u32 m0, s60, 143360
    s_add_u32 s96, s66, 28672
    buffer_load_dwordx4 v16, s[8:11], s96 offen lds
    s_waitcnt vmcnt(20)
    s_barrier
    s_add_u32 m0, s60, 0
    s_add_u32 s96, s66, 32768
    buffer_load_dwordx4 v16, s[8:11], s96 offen lds
    s_add_u32 m0, s60, 4096
    s_add_u32 s96, s66, 36864
    buffer_load_dwordx4 v16, s[8:11], s96 offen lds
    s_add_u32 m0, s60, 8192
    s_add_u32 s96, s66, 40960
    buffer_load_dwordx4 v16, s[8:11], s96 offen lds
    s_add_u32 m0, s60, 12288
    s_add_u32 s96, s66, 45056
    buffer_load_dwordx4 v16, s[8:11], s96 offen lds
    s_add_u32 m0, s60, 16384
    s_add_u32 s96, s66, 49152
    buffer_load_dwordx4 v16, s[8:11], s96 offen lds
    s_add_u32 m0, s60, 20480
    s_add_u32 s96, s66, 53248
    buffer_load_dwordx4 v16, s[8:11], s96 offen lds
    s_waitcnt vmcnt(20)
    s_barrier
    s_add_u32 m0, s60, 24576
    s_add_u32 s96, s66, 57344
    buffer_load_dwordx4 v16, s[8:11], s96 offen lds
    s_add_u32 m0, s60, 28672
    s_add_u32 s96, s66, 61440
    buffer_load_dwordx4 v16, s[8:11], s96 offen lds
    s_add_u32 m0, s60, 32768
    s_add_u32 s96, s66, 65536
    buffer_load_dwordx4 v16, s[8:11], s96 offen lds
    s_add_u32 m0, s60, 36864
    s_add_u32 s96, s66, 69632
    buffer_load_dwordx4 v16, s[8:11], s96 offen lds
    s_add_u32 m0, s60, 40960
    s_add_u32 s96, s66, 73728
    buffer_load_dwordx4 v16, s[8:11], s96 offen lds
    s_add_u32 m0, s60, 45056
    s_add_u32 s96, s66, 77824
    buffer_load_dwordx4 v16, s[8:11], s96 offen lds
    s_waitcnt vmcnt(20)
    s_barrier
    s_add_u32 m0, s60, 49152
    s_add_u32 s96, s66, 81920
    buffer_load_dwordx4 v16, s[8:11], s96 offen lds
    s_add_u32 m0, s60, 53248
    s_add_u32 s96, s66, 86016
    buffer_load_dwordx4 v16, s[8:11], s96 offen lds
    s_add_u32 m0, s60, 57344
    s_add_u32 s96, s66, 90112
    buffer_load_dwordx4 v16, s[8:11], s96 offen lds
    s_add_u32 m0, s60, 61440
    s_add_u32 s96, s66, 94208
    buffer_load_dwordx4 v16, s[8:11], s96 offen lds
    s_add_u32 m0, s60, 65536
    s_add_u32 s96, s66, 98304
    buffer_load_dwordx4 v16, s[8:11], s96 offen lds
    s_add_u32 m0, s60, 69632
    s_add_u32 s96, s66, 102400
    buffer_load_dwordx4 v16, s[8:11], s96 offen lds
    s_barrier
    s_add_u32 m0, s60, 73728
    s_add_u32 s96, s66, 106496
    buffer_load_dwordx4 v16, s[8:11], s96 offen lds
    s_add_u32 m0, s60, 77824
    s_add_u32 s96, s66, 110592
    buffer_load_dwordx4 v16, s[8:11], s96 offen lds
    s_add_u32 m0, s60, 81920
    s_add_u32 s96, s66, 114688
    buffer_load_dwordx4 v16, s[8:11], s96 offen lds
    s_add_u32 m0, s60, 86016
    s_add_u32 s96, s66, 118784
    buffer_load_dwordx4 v16, s[8:11], s96 offen lds
    s_add_u32 m0, s60, 90112
    s_add_u32 s96, s66, 122880
    buffer_load_dwordx4 v16, s[8:11], s96 offen lds
    s_add_u32 m0, s60, 94208
    s_add_u32 s96, s66, 126976
    buffer_load_dwordx4 v16, s[8:11], s96 offen lds
    s_add_u32 m0, s60, 98304
    s_add_u32 s96, s66, 131072
    buffer_load_dwordx4 v16, s[8:11], s96 offen lds
    s_add_u32 m0, s60, 102400
    s_add_u32 s96, s66, 135168
    buffer_load_dwordx4 v16, s[8:11], s96 offen lds
    s_add_u32 m0, s60, 106496
    s_add_u32 s96, s66, 139264
    buffer_load_dwordx4 v16, s[8:11], s96 offen lds
    s_add_u32 m0, s60, 110592
    s_add_u32 s96, s66, 143360
    buffer_load_dwordx4 v16, s[8:11], s96 offen lds
    s_add_u32 m0, s60, 114688
    s_add_u32 s96, s66, 147456
    buffer_load_dwordx4 v16, s[8:11], s96 offen lds
    s_add_u32 m0, s60, 118784
    s_add_u32 s96, s66, 151552
    buffer_load_dwordx4 v16, s[8:11], s96 offen lds
    s_barrier
    s_waitcnt vmcnt(0)
    s_barrier
    s_barrier
    s_add_u32 m0, s60, 147456
    s_add_u32 s96, s66, 155648
    buffer_load_dwordx4 v16, s[8:11], s96 offen lds
    s_add_u32 m0, s60, 151552
    s_add_u32 s96, s66, 159744
    buffer_load_dwordx4 v16, s[8:11], s96 offen lds
    s_add_u32 m0, s60, 122880
    s_add_u32 s96, s66, 163840
    buffer_load_dwordx4 v16, s[8:11], s96 offen lds
    s_add_u32 m0, s60, 126976
    s_add_u32 s96, s66, 167936
    buffer_load_dwordx4 v16, s[8:11], s96 offen lds
    s_add_u32 m0, s60, 131072
    s_add_u32 s96, s66, 172032
    buffer_load_dwordx4 v16, s[8:11], s96 offen lds
    s_waitcnt vmcnt(0)
    s_barrier
    s_cmp_lg_u32 s48, 0
    s_cbranch_scc1 L_lnow1_70
    s_add_u32 m0, s59, 0
    s_mov_b32 s96, 0
    buffer_load_dwordx4 v10, s[16:19], s96 offen lds
    buffer_load_dwordx4 v10, s[16:19], s96 offen offset:1024 lds
    buffer_load_dwordx4 v10, s[16:19], s96 offen offset:2048 lds
    s_add_u32 m0, s59, 12288
    s_mov_b32 s96, 98304
    buffer_load_dwordx4 v10, s[16:19], s96 offen lds
    buffer_load_dwordx4 v10, s[16:19], s96 offen offset:1024 lds
    buffer_load_dwordx4 v10, s[16:19], s96 offen offset:2048 lds
    s_add_u32 m0, s59, 24576
    s_mov_b32 s96, 196608
    buffer_load_dwordx4 v10, s[16:19], s96 offen lds
    buffer_load_dwordx4 v10, s[16:19], s96 offen offset:1024 lds
    buffer_load_dwordx4 v10, s[16:19], s96 offen offset:2048 lds
    s_add_u32 m0, s59, 36864
    s_mov_b32 s96, 294912
    buffer_load_dwordx4 v10, s[16:19], s96 offen lds
    buffer_load_dwordx4 v10, s[16:19], s96 offen offset:1024 lds
    buffer_load_dwordx4 v10, s[16:19], s96 offen offset:2048 lds
    s_add_u32 m0, s59, 49152
    s_mov_b32 s96, 393216
    buffer_load_dwordx4 v10, s[16:19], s96 offen lds
    buffer_load_dwordx4 v10, s[16:19], s96 offen offset:1024 lds
    buffer_load_dwordx4 v10, s[16:19], s96 offen offset:2048 lds
    s_add_u32 m0, s59, 61440
    s_mov_b32 s96, 491520
    buffer_load_dwordx4 v10, s[16:19], s96 offen lds
    buffer_load_dwordx4 v10, s[16:19], s96 offen offset:1024 lds
    buffer_load_dwordx4 v10, s[16:19], s96 offen offset:2048 lds
L_lnow1_70:
    s_nop 1
    s_barrier
    s_cmp_lg_u32 s48, 0
    s_cbranch_scc1 L_lend
    s_barrier
    s_mov_b32 s48, 1
    s_mov_b32 s49, 0x200000
    s_mov_b32 s50, 0x600000
    s_mov_b32 s51, 0x20000
    s_mov_b32 s52, 0x1000
    s_branch L_llayer
L_lend:
    s_waitcnt vmcnt(0)
    s_endpgm
.section .rodata,"a"
.p2align 6
.amdhsa_kernel interleave_layers__sliding_local_dilated__geglu_ffn__prompt_kernel
  .amdhsa_next_free_vgpr 256
  .amdhsa_next_free_sgpr 102
  .amdhsa_accum_offset 256
  .amdhsa_group_segment_fixed_size 0
  .amdhsa_kernarg_size 80
  .amdhsa_user_sgpr_count 2
  .amdhsa_user_sgpr_kernarg_segment_ptr 1
  .amdhsa_system_sgpr_workgroup_id_x 1
.end_amdhsa_kernel
```
